```python
import torch

def _softmax(x, axis=-1):
    return torch.softmax(x, dim=axis)
def _gelu(x):
    return torch.nn.functional.gelu(x, approximate="tanh")
def _silu(x):
    return torch.nn.functional.silu(x)
def _sigmoid(x):
    return torch.sigmoid(x)
def _layernorm(x, axis=-1, eps=1e-5):
    m = x.mean(dim=axis, keepdim=True)
    v = x.var(dim=axis, keepdim=True, unbiased=False)
    return (x - m) / torch.sqrt(v + eps)
def _scatter_add(tgt, idx, src, axis=0):
    return tgt.clone().index_add_(axis, idx, src)
def _segment_sum(src, seg, n):
    out = torch.zeros((n,) + src.shape[1:], dtype=src.dtype)
    return out.index_add_(0, seg, src)
def _pad(x, pw):
    flat = tuple(v for pair in reversed(pw) for v in pair)
    return torch.nn.functional.pad(x, flat)

kernel_name = 'sequential_preLN__sliding_block_cached__geglu_ffn__decode'

def setup_inputs():

    _w = (lambda a: (lambda t: t.to(torch.bfloat16) if t.is_floating_point() else t)(torch.as_tensor(a)))
    def _A_setup():
        B, Sq, D = 1, 1, 576
        Hq, Hkv, Sk, Dh = 32, 16, 65536, 128
        assert Hq % Hkv == 0, (Hq, Hkv)
        return {
            "x": _w((lambda *s: torch.randn(*s, dtype=torch.bfloat16) * 0.05)(B, Sq, D)),
            "k_cache": _w((lambda *s: torch.randn(*s, dtype=torch.bfloat16) * 3.2)(B, Hkv, Sk, Dh)),
            "v_cache": _w((lambda *s: torch.randn(*s, dtype=torch.bfloat16) * 0.4)(B, Hkv, Sk, Dh)),
            "wq": _w((lambda *s: torch.randn(*s, dtype=torch.bfloat16) * 3.2)(D, Hq * Dh) * (D ** -0.5)),
            "wo": _w((lambda *s: torch.randn(*s, dtype=torch.bfloat16) * 0.4)(Hq * Dh, D) * ((Hq * Dh) ** -0.5)),
        }
    _A_in = _A_setup()

    def _B_setup():
        B, S, D, F = 1, 1, 576, 4608
        return {
            "x": _w((lambda *s: torch.randn(*s, dtype=torch.bfloat16) * 0.05)(B, S, D)),
            "w_gate": _w((lambda *s: torch.randn(*s, dtype=torch.bfloat16) * 0.05)(D, F)),
            "w_up": _w((lambda *s: torch.randn(*s, dtype=torch.bfloat16) * 0.05)(D, F)),
            "w_down": _w((lambda *s: torch.randn(*s, dtype=torch.bfloat16) * 0.05)(F, D)),
        }
    _B_in = _B_setup()

    return {
        "A_x": _A_in["x"],
        "A_k_cache": _A_in["k_cache"],
        "A_v_cache": _A_in["v_cache"],
        "A_wq": _A_in["wq"],
        "A_wo": _A_in["wo"],
        "B_x": _B_in["x"],
        "B_w_gate": _B_in["w_gate"],
        "B_w_up": _B_in["w_up"],
        "B_w_down": _B_in["w_down"],
    }

def reference(A_x, A_k_cache, A_v_cache, A_wq, A_wo, B_x, B_w_gate, B_w_up, B_w_down):
    def _A_ref(x, k_cache, v_cache, wq, wo):
        B, Sq, D = x.shape
        Hq, Dh = 32, 128
        Hkv, Sk = k_cache.shape[1], k_cache.shape[2]
        W = min(4096, max(256, Sk // 4))
        rep = Hq // Hkv
        q = (lambda x, *d: x.permute(*d))((x @ wq).reshape(B, Sq, Hq, Dh), 0, 2, 1, 3)
        k = (lambda x, n, axis: torch.repeat_interleave(x, n, dim=axis))(k_cache[:, :, Sk - W:, :], rep, axis=1)
        v = (lambda x, n, axis: torch.repeat_interleave(x, n, dim=axis))(v_cache[:, :, Sk - W:, :], rep, axis=1)
        scores = torch.einsum("bhqd,bhkd->bhqk", q, k) * (Dh ** -0.5)
        p = _softmax(scores, axis=-1)
        o = torch.einsum("bhqk,bhkd->bhqd", p, v)
        return (lambda x, *d: x.permute(*d))(o, 0, 2, 1, 3).reshape(B, Sq, Hq * Dh) @ wo

    def _B_ref(x, w_gate, w_up, w_down):
        return (_gelu(x @ w_gate) * (x @ w_up)) @ w_down

    x = A_x
    h = x + _A_ref(_layernorm(x, axis=-1), A_k_cache, A_v_cache, A_wq, A_wo)
    h2 = h + _B_ref(_layernorm(h, axis=-1), B_w_gate, B_w_up, B_w_down)
    return h2
```

```asm
; @launch grid=(256,1,1) block=(576,1,1) lds=12544
.amdgcn_target "amdgcn-amd-amdhsa--gfx950"
.text
.set CODE_BYTES, L_code_end-sequential_preLN__sliding_block_cached__geglu_ffn__decode_kernel
.set PF_MASK, 15
.globl sequential_preLN__sliding_block_cached__geglu_ffn__decode_kernel
.p2align 8
.type sequential_preLN__sliding_block_cached__geglu_ffn__decode_kernel,@function
sequential_preLN__sliding_block_cached__geglu_ffn__decode_kernel:
  s_cmp_ge_u32 s2, 256
  s_cbranch_scc1 L_end
  s_load_dwordx16 s[4:19], s[0:1], 0
  s_load_dwordx8 s[20:27], s[0:1], 64
  v_lshrrev_b32 v1, 6, v0
  v_and_b32 v0, 63, v0
  v_readfirstlane_b32 s3, v1
  s_cmp_lt_u32 s2, 16
  s_cbranch_scc0 L_nopf_2
  s_getpc_b64 s[32:33]
L_pc0_1:
  s_sub_u32 s32, s32, L_pc0_1-sequential_preLN__sliding_block_cached__geglu_ffn__decode_kernel
  s_subb_u32 s33, s33, 0
  s_lshr_b32 s48, s2, 3
  s_mul_i32 s48, s48, 9
  s_add_u32 s48, s48, s3
  s_lshl_b32 s48, s48, 10
  v_lshlrev_b32 v2, 4, v0
  v_add_u32 v2, s48, v2
  v_min_u32 v2, CODE_BYTES-16, v2
  global_load_dwordx4 v[160:163], v2, s[32:33]
L_nopf_2:
  s_cmp_eq_u32 s3, 8
  s_cbranch_scc1 L_C
  s_cmp_ge_u32 s3, 6
  s_cbranch_scc1 L_T
  s_cmp_eq_u32 s3, 1
  s_cbranch_scc1 L_T
  s_cmp_ge_u32 s3, 2
  s_cbranch_scc1 L_A
  s_setprio 3
  s_and_b32 s28, s2, 7
  s_lshl_b32 s28, s28, 1
  s_bfe_u32 s29, s2, 0x10003
  s_add_u32 s28, s28, s29
  s_lshr_b32 s29, s2, 4
  s_mov_b32 s50, 0x3210CBA9
  s_mov_b32 s51, 0xFED87654
  s_lshl_b32 s29, s29, 2
  s_lshr_b64 s[50:51], s[50:51], s29
  s_and_b32 s29, s50, 15
  s_mov_b32 s30, 200000
  s_mov_b32 s58, s29
  s_mov_b32 s57, 0
L_head:
  v_lshlrev_b32 v1, 4, v0
  v_lshrrev_b32 v16, 4, v0
  v_bfe_u32 v17, v0, 3, 1
  v_and_b32 v18, 7, v0
  v_lshlrev_b32 v18, 4, v18
  v_lshl_add_u32 v19, v16, 3, v17
  v_lshl_add_u32 v2, v19, 13, v18
  v_lshl_add_u32 v19, v16, 2, v17
  v_lshl_add_u32 v3, v19, 13, v18
  s_lshr_b32 s48, s58, 2
  s_mul_i32 s49, s48, 0x120000
  s_and_b32 s50, s58, 3
  s_lshl_b32 s50, s50, 7
  s_add_u32 s49, s49, s50
  s_lshl_b32 s50, s28, 9
  s_add_u32 s49, s49, s50
  s_waitcnt lgkmcnt(0)
  s_mov_b32 s32, s4
  s_and_b32 s33, s5, 0xffff
  s_mov_b32 s34, 1152
  s_mov_b32 s35, 0x20000
  buffer_load_dwordx4 v[8:11], v1, s[32:35], 0 offen
  buffer_load_dwordx4 v[12:15], v1, s[32:35], 0 offen offset:1024
  s_add_u32 s36, s10, s49
  s_addc_u32 s37, s11, 0
  s_and_b32 s37, s37, 0xffff
  s_mov_b32 s38, 1179648
  s_mov_b32 s39, 0x20000
  s_movk_i32 s51, 0x4000
  s_mov_b32 s52, 212992
  s_mov_b32 s50, 0
  buffer_load_dwordx4 v[32:35], v2, s[36:39], s50 offen nt
  s_add_u32 s50, s50, s51
  buffer_load_dwordx4 v[36:39], v2, s[36:39], s50 offen nt
  s_add_u32 s50, s50, s51
  buffer_load_dwordx4 v[40:43], v2, s[36:39], s50 offen nt
  s_add_u32 s50, s50, s51
  buffer_load_dwordx4 v[44:47], v2, s[36:39], s50 offen nt
  s_add_u32 s50, s50, s52
  buffer_load_dwordx4 v[48:51], v2, s[36:39], s50 offen nt
  s_add_u32 s50, s50, s51
  buffer_load_dwordx4 v[52:55], v2, s[36:39], s50 offen nt
  s_add_u32 s50, s50, s51
  buffer_load_dwordx4 v[56:59], v2, s[36:39], s50 offen nt
  s_add_u32 s50, s50, s51
  buffer_load_dwordx4 v[60:63], v2, s[36:39], s50 offen nt
  s_add_u32 s50, s50, s52
  buffer_load_dwordx4 v[64:67], v2, s[36:39], s50 offen nt
  s_add_u32 s50, s50, s51
  buffer_load_dwordx4 v[68:71], v2, s[36:39], s50 offen nt
  s_add_u32 s50, s50, s51
  buffer_load_dwordx4 v[72:75], v2, s[36:39], s50 offen nt
  s_add_u32 s50, s50, s51
  buffer_load_dwordx4 v[76:79], v2, s[36:39], s50 offen nt
  s_add_u32 s50, s50, s52
  buffer_load_dwordx4 v[80:83], v2, s[36:39], s50 offen nt
  s_add_u32 s50, s50, s51
  buffer_load_dwordx4 v[84:87], v2, s[36:39], s50 offen nt
  s_add_u32 s50, s50, s51
  buffer_load_dwordx4 v[88:91], v2, s[36:39], s50 offen nt
  s_add_u32 s50, s50, s51
  buffer_load_dwordx4 v[92:95], v2, s[36:39], s50 offen nt
  s_add_u32 s50, s50, s52
  buffer_load_dwordx4 v[96:99], v3, s[36:39], s50 offen nt
  s_add_u32 s50, s50, s51
  buffer_load_dwordx4 v[100:103], v3, s[36:39], s50 offen nt
  s_barrier
  v_and_b32 v104, 15, v0
  v_lshrrev_b32 v105, 3, v104
  v_mul_u32_u24 v105, 0x0202, v105
  v_add_u32 v105, 0x0100, v105
  v_lshlrev_b32 v106, 16, v105
  v_or_b32 v106, 0x0c0c, v106
  v_or_b32 v105, 0x0c0c0000, v105
  v_and_b32 v107, 1, v104
  v_cmp_eq_u32 vcc, 1, v107
  s_nop 1
  v_cndmask_b32 v105, v105, v106, vcc
  v_bfe_u32 v104, v104, 1, 2
  v_mov_b32 v107, 0x0c0c0c0c
  v_cmp_eq_u32 vcc, 0, v104
  s_nop 1
  v_cndmask_b32 v4, v107, v105, vcc
  v_cmp_eq_u32 vcc, 1, v104
  s_nop 1
  v_cndmask_b32 v5, v107, v105, vcc
  v_cmp_eq_u32 vcc, 2, v104
  s_nop 1
  v_cndmask_b32 v6, v107, v105, vcc
  v_cmp_eq_u32 vcc, 3, v104
  s_nop 1
  v_cndmask_b32 v7, v107, v105, vcc
  v_lshrrev_b32 v104, 4, v0
  v_lshlrev_b32 v105, 4, v104
  v_lshlrev_b32 v106, 3, v104
  s_mul_i32 s50, s48, 288
  s_add_u32 s50, s50, 512
  v_add_u32 v150, s50, v105
  v_add_u32 v151, s50, v106
  v_and_b32 v152, 7, v0
  v_lshlrev_b32 v152, 1, v152
  v_add_u32 v152, v152, v104
  v_lshlrev_b32 v152, 4, v152
  s_lshl_b32 s49, s28, 13
  s_lshl_b32 s50, s48, 11
  s_add_u32 s49, s49, s50
  s_and_b32 s50, s58, 3
  s_lshl_b32 s50, s50, 8
  s_add_u32 s49, s49, s50
  s_add_u32 s49, s49, 1114112
  s_add_u32 s44, s26, s49
  s_addc_u32 s45, s27, 0
  s_waitcnt vmcnt(18)
  v_lshlrev_b32 v16, 16, v8
  v_and_b32 v17, 0xffff0000, v8
  v_lshlrev_b32 v18, 16, v9
  v_and_b32 v19, 0xffff0000, v9
  v_lshlrev_b32 v20, 16, v10
  v_and_b32 v21, 0xffff0000, v10
  v_lshlrev_b32 v22, 16, v11
  v_and_b32 v23, 0xffff0000, v11
  v_lshlrev_b32 v24, 16, v12
  v_and_b32 v25, 0xffff0000, v12
  v_lshlrev_b32 v26, 16, v13
  v_and_b32 v27, 0xffff0000, v13
  v_lshlrev_b32 v28, 16, v14
  v_and_b32 v29, 0xffff0000, v14
  v_lshlrev_b32 v30, 16, v15
  v_and_b32 v31, 0xffff0000, v15
  v_readlane_b32 s48, v16, 0
  s_mov_b32 s49, s48
  s_nop 0
  v_pk_add_f32 v[112:113], v[16:17], s[48:49] neg_lo:[0,1] neg_hi:[0,1]
  v_pk_add_f32 v[114:115], v[18:19], s[48:49] neg_lo:[0,1] neg_hi:[0,1]
  v_pk_add_f32 v[116:117], v[20:21], s[48:49] neg_lo:[0,1] neg_hi:[0,1]
  v_pk_add_f32 v[118:119], v[22:23], s[48:49] neg_lo:[0,1] neg_hi:[0,1]
  v_mov_b32 v120, 0
  v_mov_b32 v121, 0
  v_mov_b32 v122, 0
  v_mov_b32 v123, 0
  v_mov_b32 v124, 0
  v_mov_b32 v125, 0
  v_mov_b32 v126, 0
  v_mov_b32 v127, 0
  s_mov_b64 exec, 0xff
  v_pk_add_f32 v[120:121], v[24:25], s[48:49] neg_lo:[0,1] neg_hi:[0,1]
  v_pk_add_f32 v[122:123], v[26:27], s[48:49] neg_lo:[0,1] neg_hi:[0,1]
  v_pk_add_f32 v[124:125], v[28:29], s[48:49] neg_lo:[0,1] neg_hi:[0,1]
  v_pk_add_f32 v[126:127], v[30:31], s[48:49] neg_lo:[0,1] neg_hi:[0,1]
  s_mov_b64 exec, -1
  v_pk_mul_f32 v[108:109], v[112:113], v[112:113]
  v_pk_add_f32 v[110:111], v[112:113], v[114:115]
  v_pk_fma_f32 v[108:109], v[114:115], v[114:115], v[108:109]
  v_pk_fma_f32 v[108:109], v[116:117], v[116:117], v[108:109]
  v_pk_fma_f32 v[108:109], v[118:119], v[118:119], v[108:109]
  v_pk_fma_f32 v[108:109], v[120:121], v[120:121], v[108:109]
  v_pk_fma_f32 v[108:109], v[122:123], v[122:123], v[108:109]
  v_pk_fma_f32 v[108:109], v[124:125], v[124:125], v[108:109]
  v_pk_fma_f32 v[108:109], v[126:127], v[126:127], v[108:109]
  v_pk_add_f32 v[110:111], v[110:111], v[116:117]
  v_pk_add_f32 v[110:111], v[110:111], v[118:119]
  v_pk_add_f32 v[110:111], v[110:111], v[120:121]
  v_pk_add_f32 v[110:111], v[110:111], v[122:123]
  v_pk_add_f32 v[110:111], v[110:111], v[124:125]
  v_pk_add_f32 v[110:111], v[110:111], v[126:127]
  v_add_f32 v105, v108, v109
  v_add_f32 v104, v110, v111
  s_nop 1
  v_add_f32_dpp v104, v104, v104 row_ror:8 row_mask:0xf bank_mask:0xf
  v_add_f32_dpp v105, v105, v105 row_ror:8 row_mask:0xf bank_mask:0xf
  s_nop 0
  v_add_f32_dpp v104, v104, v104 row_ror:4 row_mask:0xf bank_mask:0xf
  v_add_f32_dpp v105, v105, v105 row_ror:4 row_mask:0xf bank_mask:0xf
  s_nop 0
  v_add_f32_dpp v104, v104, v104 row_ror:2 row_mask:0xf bank_mask:0xf
  v_add_f32_dpp v105, v105, v105 row_ror:2 row_mask:0xf bank_mask:0xf
  s_nop 0
  v_add_f32_dpp v104, v104, v104 row_ror:1 row_mask:0xf bank_mask:0xf
  v_add_f32_dpp v105, v105, v105 row_ror:1 row_mask:0xf bank_mask:0xf
  v_mov_b32 v106, v104
  v_mov_b32 v107, v105
  s_nop 0
  v_permlane16_swap_b32 v104, v106
  v_permlane16_swap_b32 v105, v107
  v_add_f32 v104, v104, v106
  v_add_f32 v105, v105, v107
  v_mov_b32 v106, v104
  v_mov_b32 v107, v105
  s_nop 0
  v_permlane32_swap_b32 v104, v106
  v_permlane32_swap_b32 v105, v107
  v_add_f32 v104, v104, v106
  v_add_f32 v105, v105, v107
  v_mul_f32 v104, 0x3ae38e39, v104
  v_mul_f32 v105, 0x3ae38e39, v105
  v_fma_f32 v105, -v104, v104, v105
  v_add_f32 v104, s48, v104
  v_max_f32 v105, 0, v105
  v_cvt_pk_bf16_f32 v106, v104, v105
  v_and_b32 v105, 0xffff0000, v106
  v_lshlrev_b32 v108, 16, v106
  v_add_f32 v105, 0x3727c5ac, v105
  v_mov_b32 v109, v108
  v_cvt_pk_bf16_f32 v106, v105, v105
  v_lshlrev_b32 v105, 16, v106
  v_sqrt_f32 v105, v105
  v_pk_add_f32 v[112:113], v[16:17], v[108:109] neg_lo:[0,1] neg_hi:[0,1]
  v_pk_add_f32 v[114:115], v[18:19], v[108:109] neg_lo:[0,1] neg_hi:[0,1]
  v_pk_add_f32 v[116:117], v[20:21], v[108:109] neg_lo:[0,1] neg_hi:[0,1]
  v_pk_add_f32 v[118:119], v[22:23], v[108:109] neg_lo:[0,1] neg_hi:[0,1]
  v_pk_add_f32 v[120:121], v[24:25], v[108:109] neg_lo:[0,1] neg_hi:[0,1]
  v_pk_add_f32 v[122:123], v[26:27], v[108:109] neg_lo:[0,1] neg_hi:[0,1]
  v_pk_add_f32 v[124:125], v[28:29], v[108:109] neg_lo:[0,1] neg_hi:[0,1]
  v_pk_add_f32 v[126:127], v[30:31], v[108:109] neg_lo:[0,1] neg_hi:[0,1]
  v_cvt_pk_bf16_f32 v106, v105, v105
  v_lshlrev_b32 v105, 16, v106
  v_rcp_f32 v110, v105
  v_cvt_pk_bf16_f32 v16, v112, v113
  v_cvt_pk_bf16_f32 v18, v114, v115
  v_cvt_pk_bf16_f32 v20, v116, v117
  v_cvt_pk_bf16_f32 v22, v118, v119
  v_cvt_pk_bf16_f32 v24, v120, v121
  v_cvt_pk_bf16_f32 v26, v122, v123
  v_cvt_pk_bf16_f32 v28, v124, v125
  v_cvt_pk_bf16_f32 v30, v126, v127
  v_mov_b32 v111, v110
  v_lshlrev_b32 v112, 16, v16
  v_and_b32 v113, 0xffff0000, v16
  v_lshlrev_b32 v114, 16, v18
  v_and_b32 v115, 0xffff0000, v18
  v_lshlrev_b32 v116, 16, v20
  v_and_b32 v117, 0xffff0000, v20
  v_lshlrev_b32 v118, 16, v22
  v_and_b32 v119, 0xffff0000, v22
  v_lshlrev_b32 v120, 16, v24
  v_and_b32 v121, 0xffff0000, v24
  v_lshlrev_b32 v122, 16, v26
  v_and_b32 v123, 0xffff0000, v26
  v_lshlrev_b32 v124, 16, v28
  v_and_b32 v125, 0xffff0000, v28
  v_lshlrev_b32 v126, 16, v30
  v_and_b32 v127, 0xffff0000, v30
  v_pk_mul_f32 v[112:113], v[112:113], v[110:111]
  v_pk_mul_f32 v[114:115], v[114:115], v[110:111]
  v_pk_mul_f32 v[116:117], v[116:117], v[110:111]
  v_pk_mul_f32 v[118:119], v[118:119], v[110:111]
  v_pk_mul_f32 v[120:121], v[120:121], v[110:111]
  v_pk_mul_f32 v[122:123], v[122:123], v[110:111]
  v_pk_mul_f32 v[124:125], v[124:125], v[110:111]
  v_pk_mul_f32 v[126:127], v[126:127], v[110:111]
  v_cvt_pk_bf16_f32 v8, v112, v113
  v_cvt_pk_bf16_f32 v9, v114, v115
  v_cvt_pk_bf16_f32 v10, v116, v117
  v_cvt_pk_bf16_f32 v11, v118, v119
  v_cvt_pk_bf16_f32 v12, v120, v121
  v_cvt_pk_bf16_f32 v13, v122, v123
  v_cvt_pk_bf16_f32 v14, v124, v125
  v_cvt_pk_bf16_f32 v15, v126, v127
  ds_write_b128 v1, v[8:11] offset:512
  s_mov_b64 exec, 0xff
  ds_write_b128 v1, v[12:15] offset:1536
  s_mov_b64 exec, -1
  s_waitcnt lgkmcnt(0)
  ds_read_b128 v[108:111], v150 offset:0
  ds_read_b128 v[112:115], v150 offset:64
  ds_read_b128 v[116:119], v150 offset:128
  ds_read_b128 v[120:123], v150 offset:192
  ds_read_b64 v[124:125], v151 offset:256
  s_waitcnt lgkmcnt(4)
  v_perm_b32 v20, v108, v108, v4
  v_perm_b32 v21, v108, v108, v5
  v_perm_b32 v22, v108, v108, v6
  v_perm_b32 v23, v108, v108, v7
  v_perm_b32 v24, v109, v109, v4
  v_perm_b32 v25, v109, v109, v5
  v_perm_b32 v26, v109, v109, v6
  v_perm_b32 v27, v109, v109, v7
  s_waitcnt vmcnt(17)
  v_mfma_f32_16x16x32_bf16 v[16:19], v[20:23], v[32:35], 0
  v_perm_b32 v20, v110, v110, v4
  v_perm_b32 v21, v110, v110, v5
  v_perm_b32 v22, v110, v110, v6
  v_perm_b32 v23, v110, v110, v7
  s_waitcnt vmcnt(16)
  v_mfma_f32_16x16x32_bf16 v[16:19], v[24:27], v[36:39], v[16:19]
  v_perm_b32 v24, v111, v111, v4
  v_perm_b32 v25, v111, v111, v5
  v_perm_b32 v26, v111, v111, v6
  v_perm_b32 v27, v111, v111, v7
  s_waitcnt vmcnt(15)
  v_mfma_f32_16x16x32_bf16 v[16:19], v[20:23], v[40:43], v[16:19]
  s_waitcnt lgkmcnt(3)
  v_perm_b32 v20, v112, v112, v4
  v_perm_b32 v21, v112, v112, v5
  v_perm_b32 v22, v112, v112, v6
  v_perm_b32 v23, v112, v112, v7
  s_waitcnt vmcnt(14)
  v_mfma_f32_16x16x32_bf16 v[16:19], v[24:27], v[44:47], v[16:19]
  v_perm_b32 v24, v113, v113, v4
  v_perm_b32 v25, v113, v113, v5
  v_perm_b32 v26, v113, v113, v6
  v_perm_b32 v27, v113, v113, v7
  s_waitcnt vmcnt(13)
  v_mfma_f32_16x16x32_bf16 v[16:19], v[20:23], v[48:51], v[16:19]
  v_perm_b32 v20, v114, v114, v4
  v_perm_b32 v21, v114, v114, v5
  v_perm_b32 v22, v114, v114, v6
  v_perm_b32 v23, v114, v114, v7
  s_waitcnt vmcnt(12)
  v_mfma_f32_16x16x32_bf16 v[16:19], v[24:27], v[52:55], v[16:19]
  v_perm_b32 v24, v115, v115, v4
  v_perm_b32 v25, v115, v115, v5
  v_perm_b32 v26, v115, v115, v6
  v_perm_b32 v27, v115, v115, v7
  s_waitcnt vmcnt(11)
  v_mfma_f32_16x16x32_bf16 v[16:19], v[20:23], v[56:59], v[16:19]
  s_waitcnt lgkmcnt(2)
  v_perm_b32 v20, v116, v116, v4
  v_perm_b32 v21, v116, v116, v5
  v_perm_b32 v22, v116, v116, v6
  v_perm_b32 v23, v116, v116, v7
  s_waitcnt vmcnt(10)
  v_mfma_f32_16x16x32_bf16 v[16:19], v[24:27], v[60:63], v[16:19]
  v_perm_b32 v24, v117, v117, v4
  v_perm_b32 v25, v117, v117, v5
  v_perm_b32 v26, v117, v117, v6
  v_perm_b32 v27, v117, v117, v7
  s_waitcnt vmcnt(9)
  v_mfma_f32_16x16x32_bf16 v[16:19], v[20:23], v[64:67], v[16:19]
  v_perm_b32 v20, v118, v118, v4
  v_perm_b32 v21, v118, v118, v5
  v_perm_b32 v22, v118, v118, v6
  v_perm_b32 v23, v118, v118, v7
  s_waitcnt vmcnt(8)
  v_mfma_f32_16x16x32_bf16 v[16:19], v[24:27], v[68:71], v[16:19]
  v_perm_b32 v24, v119, v119, v4
  v_perm_b32 v25, v119, v119, v5
  v_perm_b32 v26, v119, v119, v6
  v_perm_b32 v27, v119, v119, v7
  s_waitcnt vmcnt(7)
  v_mfma_f32_16x16x32_bf16 v[16:19], v[20:23], v[72:75], v[16:19]
  s_waitcnt lgkmcnt(1)
  v_perm_b32 v20, v120, v120, v4
  v_perm_b32 v21, v120, v120, v5
  v_perm_b32 v22, v120, v120, v6
  v_perm_b32 v23, v120, v120, v7
  s_waitcnt vmcnt(6)
  v_mfma_f32_16x16x32_bf16 v[16:19], v[24:27], v[76:79], v[16:19]
  v_perm_b32 v24, v121, v121, v4
  v_perm_b32 v25, v121, v121, v5
  v_perm_b32 v26, v121, v121, v6
  v_perm_b32 v27, v121, v121, v7
  s_waitcnt vmcnt(5)
  v_mfma_f32_16x16x32_bf16 v[16:19], v[20:23], v[80:83], v[16:19]
  v_perm_b32 v20, v122, v122, v4
  v_perm_b32 v21, v122, v122, v5
  v_perm_b32 v22, v122, v122, v6
  v_perm_b32 v23, v122, v122, v7
  s_waitcnt vmcnt(4)
  v_mfma_f32_16x16x32_bf16 v[16:19], v[24:27], v[84:87], v[16:19]
  v_perm_b32 v24, v123, v123, v4
  v_perm_b32 v25, v123, v123, v5
  v_perm_b32 v26, v123, v123, v6
  v_perm_b32 v27, v123, v123, v7
  s_waitcnt vmcnt(3)
  v_mfma_f32_16x16x32_bf16 v[16:19], v[20:23], v[88:91], v[16:19]
  s_waitcnt lgkmcnt(0)
  v_perm_b32 v20, v124, v124, v4
  v_perm_b32 v21, v124, v124, v5
  v_perm_b32 v22, v124, v124, v6
  v_perm_b32 v23, v124, v124, v7
  s_waitcnt vmcnt(2)
  v_mfma_f32_16x16x32_bf16 v[16:19], v[24:27], v[92:95], v[16:19]
  v_perm_b32 v24, v125, v125, v4
  v_perm_b32 v25, v125, v125, v5
  v_perm_b32 v26, v125, v125, v6
  v_perm_b32 v27, v125, v125, v7
  s_waitcnt vmcnt(1)
  v_mfma_f32_16x16x32_bf16 v[16:19], v[20:23], v[96:99], v[16:19]
  s_waitcnt vmcnt(0)
  v_mfma_f32_16x16x32_bf16 v[16:19], v[24:27], v[100:103], v[16:19]
  v_mov_b32 v29, 0
  s_nop 5
L_spin_3:
  ds_read_b32 v28, v29
  s_cmp_eq_u32 s30, 0
  s_cbranch_scc1 L_spun_4
  s_sub_u32 s30, s30, 1
  s_waitcnt lgkmcnt(0)
  v_readfirstlane_b32 s51, v28
  s_cmp_ge_u32 s51, 1
  s_cbranch_scc0 L_spin_3
L_spun_4:
  s_waitcnt lgkmcnt(0)
  v_mov_b32 v28, 48
  ds_read_b32 v30, v28
  v_mov_b32 v20, v16
  v_mov_b32 v21, v17
  v_mov_b32 v22, v18
  v_mov_b32 v23, v19
  v_permlane32_swap_b32 v16, v20
  v_permlane32_swap_b32 v17, v21
  v_permlane32_swap_b32 v18, v22
  v_permlane32_swap_b32 v19, v23
  v_add_f32_dpp v16, v20, v16 row_ror:8 row_mask:0xf bank_mask:0xf
  v_add_f32_dpp v17, v21, v17 row_ror:8 row_mask:0xf bank_mask:0xf
  v_add_f32_dpp v18, v22, v18 row_ror:8 row_mask:0xf bank_mask:0xf
  v_add_f32_dpp v19, v23, v19 row_ror:8 row_mask:0xf bank_mask:0xf
  s_waitcnt lgkmcnt(0)
  v_mov_b32 v28, v16
  v_mov_b32 v29, v17
  v_mov_b32 v31, v30
  v_mov_b32 v20, v18
  v_mov_b32 v21, v19
  v_mov_b32 v22, v30
  v_mov_b32 v23, v30
  s_mov_b32 exec_lo, 0x00ff00ff
  s_mov_b32 exec_hi, 0
  global_store_dwordx4 v152, v[28:31], s[44:45] sc1
  global_store_dwordx4 v152, v[20:23], s[44:45] offset:1024 sc1
  s_mov_b64 exec, -1
  s_cmp_eq_u32 s57, 1
  s_cbranch_scc1 L_T_exit
  s_mov_b32 s3, 0
  s_branch L_Tail
L_T_exit:
  s_endpgm
.p2align 6
L_A:
  s_setprio 2
  s_and_b32 s28, s2, 7
  s_lshl_b32 s28, s28, 1
  s_bfe_u32 s29, s2, 0x10003
  s_add_u32 s28, s28, s29
  s_lshr_b32 s29, s2, 4
  s_mov_b32 s50, 0x3210CBA9
  s_mov_b32 s51, 0xFED87654
  s_lshl_b32 s29, s29, 2
  s_lshr_b64 s[50:51], s[50:51], s29
  s_and_b32 s29, s50, 15
  s_mov_b32 s30, 200000
  s_sub_u32 s3, s3, 2
  v_bfe_u32 v8, v0, 1, 3
  v_lshlrev_b32 v8, 8, v8
  v_lshrrev_b32 v9, 4, v0
  v_and_b32 v10, 1, v0
  v_lshl_add_u32 v11, v9, 1, v10
  v_lshl_add_u32 v1, v11, 4, v8
  s_lshl_b32 s49, s3, 4
  s_add_u32 s49, s49, s29
  s_lshl_b32 s48, s28, 24
  s_add_u32 s48, s48, 15728640
  v_xor_b32 v10, 1, v10
  v_lshl_add_u32 v11, v9, 1, v10
  v_lshl_add_u32 v2, v11, 4, v8
  s_lshl_b32 s40, s49, 11
  s_add_u32 s50, s49, 17
  s_and_b32 s50, s50, 63
  s_add_u32 s50, s50, 64
  s_lshl_b32 s41, s50, 11
  s_add_u32 s50, s49, 34
  s_and_b32 s50, s50, 63
  s_add_u32 s50, s50, 128
  s_lshl_b32 s42, s50, 11
  s_add_u32 s50, s49, 51
  s_and_b32 s50, s50, 63
  s_add_u32 s50, s50, 192
  s_lshl_b32 s43, s50, 11
  s_add_u32 s50, s49, 68
  s_and_b32 s50, s50, 63
  s_add_u32 s50, s50, 256
  s_lshl_b32 s44, s50, 11
  s_add_u32 s50, s49, 85
  s_and_b32 s50, s50, 63
  s_add_u32 s50, s50, 320
  s_lshl_b32 s45, s50, 11
  s_add_u32 s50, s49, 102
  s_and_b32 s50, s50, 63
  s_add_u32 s50, s50, 384
  s_lshl_b32 s46, s50, 11
  s_add_u32 s50, s49, 119
  s_and_b32 s50, s50, 63
  s_add_u32 s50, s50, 448
  s_lshl_b32 s47, s50, 11
  s_waitcnt lgkmcnt(0)
  s_add_u32 s32, s6, s48
  s_addc_u32 s33, s7, 0
  s_and_b32 s33, s33, 0xffff
  s_mov_b32 s34, 1048576
  s_mov_b32 s35, 0x20000
  s_barrier
  buffer_load_dwordx4 v[40:43], v1, s[32:35], s40 offen offset:0 nt
  buffer_load_dwordx4 v[44:47], v1, s[32:35], s40 offen offset:128 nt
  buffer_load_dwordx4 v[48:51], v2, s[32:35], s41 offen offset:0 nt
  buffer_load_dwordx4 v[52:55], v2, s[32:35], s41 offen offset:128 nt
  buffer_load_dwordx4 v[56:59], v1, s[32:35], s42 offen offset:0 nt
  buffer_load_dwordx4 v[60:63], v1, s[32:35], s42 offen offset:128 nt
  buffer_load_dwordx4 v[64:67], v2, s[32:35], s43 offen offset:0 nt
  v_mov_b32 v3, s40
  v_cmp_eq_u32 vcc, 1, v9
  v_mov_b32 v11, s42
  s_nop 0
  v_cndmask_b32 v3, v3, v11, vcc
  v_cmp_eq_u32 vcc, 2, v9
  v_mov_b32 v11, s44
  s_nop 0
  v_cndmask_b32 v3, v3, v11, vcc
  v_cmp_eq_u32 vcc, 3, v9
  v_mov_b32 v11, s46
  s_nop 0
  v_cndmask_b32 v3, v3, v11, vcc
  v_and_b32 v10, 15, v0
  v_lshl_add_u32 v3, v10, 4, v3
  v_mov_b32 v31, s41
  v_cmp_eq_u32 vcc, 1, v9
  v_mov_b32 v11, s43
  s_nop 0
  v_cndmask_b32 v31, v31, v11, vcc
  v_cmp_eq_u32 vcc, 2, v9
  v_mov_b32 v11, s45
  s_nop 0
  v_cndmask_b32 v31, v31, v11, vcc
  v_cmp_eq_u32 vcc, 3, v9
  v_mov_b32 v11, s47
  s_nop 0
  v_cndmask_b32 v31, v31, v11, vcc
  v_and_b32 v10, 15, v0
  v_lshl_add_u32 v31, v10, 4, v31
  s_add_u32 s36, s8, s48
  s_addc_u32 s37, s9, 0
  s_and_b32 s37, s37, 0xffff
  s_mov_b32 s38, 1048576
  s_mov_b32 s39, 0x20000
  v_and_b32 v20, 15, v0
  v_lshrrev_b32 v21, 3, v20
  v_mul_u32_u24 v21, 0x0202, v21
  v_add_u32 v21, 0x0100, v21
  v_lshlrev_b32 v22, 16, v21
  v_or_b32 v22, 0x0c0c, v22
  v_or_b32 v21, 0x0c0c0000, v21
  v_and_b32 v23, 1, v20
  v_cmp_eq_u32 vcc, 1, v23
  s_nop 1
  v_cndmask_b32 v21, v21, v22, vcc
  v_bfe_u32 v20, v20, 1, 2
  v_mov_b32 v23, 0x0c0c0c0c
  v_cmp_eq_u32 vcc, 0, v20
  s_nop 1
  v_cndmask_b32 v4, v23, v21, vcc
  v_cmp_eq_u32 vcc, 1, v20
  s_nop 1
  v_cndmask_b32 v5, v23, v21, vcc
  v_cmp_eq_u32 vcc, 2, v20
  s_nop 1
  v_cndmask_b32 v6, v23, v21, vcc
  v_cmp_eq_u32 vcc, 3, v20
  s_nop 1
  v_cndmask_b32 v7, v23, v21, vcc
  v_and_b32 v20, 1, v0
  v_lshlrev_b32 v20, 8, v20
  v_bfe_u32 v21, v0, 1, 1
  v_lshl_add_u32 v21, v9, 1, v21
  v_lshl_add_u32 v35, v21, 4, v20
  s_mov_b32 s56, 0xaaaaaaaa
  s_mov_b32 s57, 0xaaaaaaaa
  v_and_b32 v20, 15, v0
  v_lshlrev_b32 v20, 1, v20
  v_and_b32 v21, 1, v9
  v_add_u32 v20, v20, v21
  v_lshrrev_b32 v21, 1, v9
  v_lshl_add_u32 v20, v21, 5, v20
  s_lshl_b32 s49, s3, 10
  s_add_u32 s49, s49, 2560
  v_lshl_add_u32 v36, v20, 4, s49
  v_lshlrev_b32 v20, 12, v9
  v_and_b32 v21, 15, v0
  v_lshl_add_u32 v37, v21, 4, v20
  s_lshl_b32 s49, s28, 14
  s_lshl_b32 s50, s29, 8
  s_add_u32 s49, s49, s50
  s_add_u32 s49, s49, 131072
  s_add_u32 s52, s26, s49
  s_addc_u32 s53, s27, 0
  s_lshl_b32 s49, s28, 10
  s_lshl_b32 s50, s29, 4
  s_add_u32 s49, s49, s50
  s_add_u32 s49, s49, 65536
  s_add_u32 s54, s26, s49
  s_addc_u32 s55, s27, 0
  s_waitcnt vmcnt(6)
  buffer_load_dwordx4 v[68:71], v2, s[32:35], s43 offen offset:128 nt
  s_waitcnt vmcnt(6)
  buffer_load_dwordx4 v[72:75], v1, s[32:35], s44 offen offset:0 nt
  s_waitcnt vmcnt(6)
  buffer_load_dwordx4 v[76:79], v1, s[32:35], s44 offen offset:128 nt
  s_waitcnt vmcnt(6)
  buffer_load_dwordx4 v[80:83], v2, s[32:35], s45 offen offset:0 nt
  s_waitcnt vmcnt(6)
  buffer_load_dwordx4 v[84:87], v2, s[32:35], s45 offen offset:128 nt
  s_waitcnt vmcnt(6)
  buffer_load_dwordx4 v[88:91], v1, s[32:35], s46 offen offset:0 nt
  s_waitcnt vmcnt(6)
  buffer_load_dwordx4 v[92:95], v1, s[32:35], s46 offen offset:128 nt
  s_waitcnt vmcnt(6)
  buffer_load_dwordx4 v[96:99], v2, s[32:35], s47 offen offset:0 nt
  s_waitcnt vmcnt(6)
  buffer_load_dwordx4 v[100:103], v2, s[32:35], s47 offen offset:128 nt
  s_waitcnt vmcnt(6)
  buffer_load_dwordx4 v[104:107], v3, s[36:39], 0 offen offset:0 nt
  v_mov_b32 v38, 40
  v_mov_b32 v39, 1
  s_mov_b64 exec, 1
  ds_add_u32 v38, v39
  s_mov_b64 exec, -1
  s_waitcnt vmcnt(6)
  buffer_load_dwordx4 v[108:111], v31, s[36:39], 0 offen offset:0 nt
  s_waitcnt vmcnt(6)
  buffer_load_dwordx4 v[112:115], v3, s[36:39], 0 offen offset:256 nt
  s_waitcnt vmcnt(6)
  buffer_load_dwordx4 v[116:119], v31, s[36:39], 0 offen offset:256 nt
  s_waitcnt vmcnt(6)
  buffer_load_dwordx4 v[120:123], v3, s[36:39], 0 offen offset:512 nt
  s_waitcnt vmcnt(6)
  buffer_load_dwordx4 v[124:127], v31, s[36:39], 0 offen offset:512 nt
  s_waitcnt vmcnt(6)
  buffer_load_dwordx4 v[128:131], v3, s[36:39], 0 offen offset:768 nt
  s_waitcnt vmcnt(6)
  buffer_load_dwordx4 v[132:135], v31, s[36:39], 0 offen offset:768 nt
  v_mov_b32 v38, 12
  v_mov_b32 v39, 1
  s_mov_b64 exec, 1
  ds_add_u32 v38, v39
  s_mov_b64 exec, -1
  s_waitcnt vmcnt(6)
  buffer_load_dwordx4 v[136:139], v3, s[36:39], 0 offen offset:1024 nt
  s_waitcnt vmcnt(6)
  buffer_load_dwordx4 v[140:143], v31, s[36:39], 0 offen offset:1024 nt
  s_waitcnt vmcnt(6)
  buffer_load_dwordx4 v[144:147], v3, s[36:39], 0 offen offset:1280 nt
  s_waitcnt vmcnt(6)
  buffer_load_dwordx4 v[148:151], v31, s[36:39], 0 offen offset:1280 nt
  s_waitcnt vmcnt(6)
  buffer_load_dwordx4 v[152:155], v3, s[36:39], 0 offen offset:1536 nt
  s_waitcnt vmcnt(6)
  buffer_load_dwordx4 v[156:159], v31, s[36:39], 0 offen offset:1536 nt
  s_waitcnt vmcnt(6)
  buffer_load_dwordx4 v[160:163], v3, s[36:39], 0 offen offset:1792 nt
  s_waitcnt vmcnt(6)
  buffer_load_dwordx4 v[164:167], v31, s[36:39], 0 offen offset:1792 nt
  v_mov_b32 v38, 16
  v_mov_b32 v39, 1
  s_mov_b64 exec, 1
  ds_add_u32 v38, v39
  s_mov_b64 exec, -1
  v_mov_b32 v39, 4
  s_nop 0
L_spin_5:
  ds_read_b32 v38, v39
  s_cmp_eq_u32 s30, 0
  s_cbranch_scc1 L_spun_6
  s_sub_u32 s30, s30, 1
  s_waitcnt lgkmcnt(0)
  v_readfirstlane_b32 s51, v38
  s_cmp_ge_u32 s51, 1
  s_cbranch_scc0 L_spin_5
L_spun_6:
  s_waitcnt lgkmcnt(0)
  v_mov_b32 v38, 48
  ds_read_b32 v39, v38
  s_movk_i32 s31, 0x3ff
  ds_read_b128 v[8:11], v35 offset:1792
  ds_read_b128 v[12:15], v35 offset:1920
  s_waitcnt lgkmcnt(0)
  v_and_b32 v39, 0x3ff, v39
  v_mfma_f32_16x16x32_bf16 v[16:19], v[8:11], v[40:43], 0
  v_mfma_f32_16x16x32_bf16 v[20:23], v[8:11], v[48:51], 0
  v_mfma_f32_16x16x32_bf16 v[16:19], v[12:15], v[44:47], v[16:19]
  v_mfma_f32_16x16x32_bf16 v[20:23], v[12:15], v[52:55], v[20:23]
  v_readfirstlane_b32 s58, v39
  v_mfma_f32_16x16x32_bf16 v[24:27], v[8:11], v[56:59], 0
  v_mfma_f32_16x16x32_bf16 v[28:31], v[8:11], v[64:67], 0
  v_mfma_f32_16x16x32_bf16 v[24:27], v[12:15], v[60:63], v[24:27]
  v_mfma_f32_16x16x32_bf16 v[28:31], v[12:15], v[68:71], v[28:31]
  s_nop 2
  v_cndmask_b32 v16, v16, v20, s[56:57]
  v_cndmask_b32 v18, v22, v18, s[56:57]
  v_cndmask_b32 v17, v17, v21, s[56:57]
  v_cndmask_b32 v19, v23, v19, s[56:57]
  v_add_f32_dpp v32, v18, v16 quad_perm:[1,0,3,2] row_mask:0x1 bank_mask:0xf
  s_nop 0
  v_add_f32_dpp v33, v19, v17 quad_perm:[1,0,3,2] row_mask:0x1 bank_mask:0xf
  v_mfma_f32_16x16x32_bf16 v[16:19], v[8:11], v[72:75], 0
  v_mfma_f32_16x16x32_bf16 v[20:23], v[8:11], v[80:83], 0
  v_mfma_f32_16x16x32_bf16 v[16:19], v[12:15], v[76:79], v[16:19]
  v_mfma_f32_16x16x32_bf16 v[20:23], v[12:15], v[84:87], v[20:23]
  v_cndmask_b32 v24, v24, v28, s[56:57]
  v_cndmask_b32 v26, v30, v26, s[56:57]
  v_cndmask_b32 v25, v25, v29, s[56:57]
  v_cndmask_b32 v27, v31, v27, s[56:57]
  v_add_f32_dpp v32, v26, v24 quad_perm:[1,0,3,2] row_mask:0x2 bank_mask:0xf
  s_nop 0
  v_add_f32_dpp v33, v27, v25 quad_perm:[1,0,3,2] row_mask:0x2 bank_mask:0xf
  v_mfma_f32_16x16x32_bf16 v[24:27], v[8:11], v[88:91], 0
  v_mfma_f32_16x16x32_bf16 v[28:31], v[8:11], v[96:99], 0
  v_mfma_f32_16x16x32_bf16 v[24:27], v[12:15], v[92:95], v[24:27]
  v_mfma_f32_16x16x32_bf16 v[28:31], v[12:15], v[100:103], v[28:31]
  v_cndmask_b32 v16, v16, v20, s[56:57]
  v_cndmask_b32 v18, v22, v18, s[56:57]
  v_cndmask_b32 v17, v17, v21, s[56:57]
  v_cndmask_b32 v19, v23, v19, s[56:57]
  v_add_f32_dpp v32, v18, v16 quad_perm:[1,0,3,2] row_mask:0x4 bank_mask:0xf
  s_nop 0
  v_add_f32_dpp v33, v19, v17 quad_perm:[1,0,3,2] row_mask:0x4 bank_mask:0xf
  s_nop 0
  v_cndmask_b32 v24, v24, v28, s[56:57]
  v_cndmask_b32 v26, v30, v26, s[56:57]
  v_cndmask_b32 v25, v25, v29, s[56:57]
  v_cndmask_b32 v27, v31, v27, s[56:57]
  v_add_f32_dpp v32, v26, v24 quad_perm:[1,0,3,2] row_mask:0x8 bank_mask:0xf
  s_nop 0
  v_add_f32_dpp v33, v27, v25 quad_perm:[1,0,3,2] row_mask:0x8 bank_mask:0xf
  v_cvt_pk_bf16_f32 v20, v32, v33
  v_lshlrev_b32 v32, 16, v20
  v_and_b32 v33, 0xffff0000, v20
  v_mul_f32 v32, 0x3db504f3, v32
  v_mul_f32 v33, 0x3db504f3, v33
  v_cvt_pk_bf16_f32 v20, v32, v33
  v_lshlrev_b32 v32, 16, v20
  v_and_b32 v33, 0xffff0000, v20
  v_mov_b32 v24, v32
  v_mov_b32 v26, v33
  s_nop 0
  v_max_f32_dpp v24, v24, v24 row_ror:8 row_mask:0xf bank_mask:0xf
  v_max_f32_dpp v26, v26, v26 row_ror:8 row_mask:0xf bank_mask:0xf
  s_nop 0
  v_max_f32_dpp v24, v24, v24 row_ror:4 row_mask:0xf bank_mask:0xf
  v_max_f32_dpp v26, v26, v26 row_ror:4 row_mask:0xf bank_mask:0xf
  s_nop 0
  v_max_f32_dpp v24, v24, v24 row_ror:2 row_mask:0xf bank_mask:0xf
  v_max_f32_dpp v26, v26, v26 row_ror:2 row_mask:0xf bank_mask:0xf
  s_nop 0
  v_max_f32_dpp v24, v24, v24 row_ror:1 row_mask:0xf bank_mask:0xf
  v_max_f32_dpp v26, v26, v26 row_ror:1 row_mask:0xf bank_mask:0xf
  v_mov_b32 v20, v24
  v_mov_b32 v21, v26
  s_nop 0
  v_permlane16_swap_b32 v24, v20
  v_permlane16_swap_b32 v26, v21
  v_max_f32 v24, v24, v20
  v_max_f32 v26, v26, v21
  v_mov_b32 v20, v24
  v_mov_b32 v21, v26
  s_nop 0
  v_permlane32_swap_b32 v24, v20
  v_permlane32_swap_b32 v26, v21
  v_max_f32 v24, v24, v20
  v_max_f32 v26, v26, v21
  v_sub_f32 v32, v32, v24
  v_sub_f32 v33, v33, v26
  v_mul_f32 v32, 0x3fb8aa3b, v32
  v_mul_f32 v33, 0x3fb8aa3b, v33
  v_exp_f32 v25, v32
  v_exp_f32 v27, v33
  s_nop 0
  v_cvt_pk_bf16_f32 v34, v25, v27
  s_nop 1
  v_mov_b32_dpp v20, v34 row_newbcast:0 row_mask:0xf bank_mask:0xf
  v_perm_b32 v8, v20, v20, v4
  v_perm_b32 v9, v20, v20, v5
  v_perm_b32 v10, v20, v20, v6
  v_perm_b32 v11, v20, v20, v7
  v_mov_b32_dpp v21, v34 row_newbcast:1 row_mask:0xf bank_mask:0xf
  v_perm_b32 v12, v21, v21, v4
  v_perm_b32 v13, v21, v21, v5
  v_perm_b32 v14, v21, v21, v6
  v_perm_b32 v15, v21, v21, v7
  v_mfma_f32_16x16x32_bf16 v[16:19], v[8:11], v[104:107], 0
  v_mov_b32_dpp v20, v34 row_newbcast:2 row_mask:0xf bank_mask:0xf
  v_perm_b32 v8, v20, v20, v4
  v_perm_b32 v9, v20, v20, v5
  v_perm_b32 v10, v20, v20, v6
  v_perm_b32 v11, v20, v20, v7
  v_mfma_f32_16x16x32_bf16 v[16:19], v[12:15], v[108:111], v[16:19]
  v_mov_b32_dpp v21, v34 row_newbcast:3 row_mask:0xf bank_mask:0xf
  v_perm_b32 v12, v21, v21, v4
  v_perm_b32 v13, v21, v21, v5
  v_perm_b32 v14, v21, v21, v6
  v_perm_b32 v15, v21, v21, v7
  v_mfma_f32_16x16x32_bf16 v[16:19], v[8:11], v[112:115], v[16:19]
  v_mov_b32_dpp v20, v34 row_newbcast:4 row_mask:0xf bank_mask:0xf
  v_perm_b32 v8, v20, v20, v4
  v_perm_b32 v9, v20, v20, v5
  v_perm_b32 v10, v20, v20, v6
  v_perm_b32 v11, v20, v20, v7
  v_mfma_f32_16x16x32_bf16 v[16:19], v[12:15], v[116:119], v[16:19]
  v_mov_b32_dpp v21, v34 row_newbcast:5 row_mask:0xf bank_mask:0xf
  v_perm_b32 v12, v21, v21, v4
  v_perm_b32 v13, v21, v21, v5
  v_perm_b32 v14, v21, v21, v6
  v_perm_b32 v15, v21, v21, v7
  v_add_f32_dpp v25, v25, v25 row_ror:8 row_mask:0xf bank_mask:0xf
  v_add_f32_dpp v27, v27, v27 row_ror:8 row_mask:0xf bank_mask:0xf
  s_nop 0
  v_add_f32_dpp v25, v25, v25 row_ror:4 row_mask:0xf bank_mask:0xf
  v_add_f32_dpp v27, v27, v27 row_ror:4 row_mask:0xf bank_mask:0xf
  s_nop 0
  v_add_f32_dpp v25, v25, v25 row_ror:2 row_mask:0xf bank_mask:0xf
  v_add_f32_dpp v27, v27, v27 row_ror:2 row_mask:0xf bank_mask:0xf
  s_nop 0
  v_add_f32_dpp v25, v25, v25 row_ror:1 row_mask:0xf bank_mask:0xf
  v_add_f32_dpp v27, v27, v27 row_ror:1 row_mask:0xf bank_mask:0xf
  v_mov_b32 v22, v25
  v_mov_b32 v23, v27
  s_nop 0
  v_permlane16_swap_b32 v25, v22
  v_permlane16_swap_b32 v27, v23
  v_add_f32 v25, v25, v22
  v_add_f32 v27, v27, v23
  v_mov_b32 v22, v25
  v_mov_b32 v23, v27
  s_nop 0
  v_permlane32_swap_b32 v25, v22
  v_permlane32_swap_b32 v27, v23
  v_add_f32 v25, v25, v22
  v_add_f32 v27, v27, v23
  s_lshl_b32 s48, s3, 4
  s_add_u32 s48, s48, 384
  v_mov_b32 v22, s48
  s_mov_b64 exec, 1
  ds_write_b128 v22, v[24:27]
  v_mov_b32 v22, 28
  v_mov_b32 v23, 1
  s_waitcnt lgkmcnt(0)
  ds_add_u32 v22, v23
  s_mov_b64 exec, -1
  v_mfma_f32_16x16x32_bf16 v[16:19], v[8:11], v[120:123], v[16:19]
  v_mov_b32_dpp v20, v34 row_newbcast:6 row_mask:0xf bank_mask:0xf
  v_perm_b32 v8, v20, v20, v4
  v_perm_b32 v9, v20, v20, v5
  v_perm_b32 v10, v20, v20, v6
  v_perm_b32 v11, v20, v20, v7
  v_mfma_f32_16x16x32_bf16 v[16:19], v[12:15], v[124:127], v[16:19]
  v_mov_b32_dpp v21, v34 row_newbcast:7 row_mask:0xf bank_mask:0xf
  v_perm_b32 v12, v21, v21, v4
  v_perm_b32 v13, v21, v21, v5
  v_perm_b32 v14, v21, v21, v6
  v_perm_b32 v15, v21, v21, v7
  v_mfma_f32_16x16x32_bf16 v[16:19], v[8:11], v[128:131], v[16:19]
  v_mov_b32_dpp v20, v34 row_newbcast:8 row_mask:0xf bank_mask:0xf
  v_perm_b32 v8, v20, v20, v4
  v_perm_b32 v9, v20, v20, v5
  v_perm_b32 v10, v20, v20, v6
  v_perm_b32 v11, v20, v20, v7
  v_mfma_f32_16x16x32_bf16 v[16:19], v[12:15], v[132:135], v[16:19]
  v_mov_b32_dpp v21, v34 row_newbcast:9 row_mask:0xf bank_mask:0xf
  v_perm_b32 v12, v21, v21, v4
  v_perm_b32 v13, v21, v21, v5
  v_perm_b32 v14, v21, v21, v6
  v_perm_b32 v15, v21, v21, v7
  v_mov_b32 v23, 28
  s_nop 0
L_spin_7:
  ds_read_b32 v22, v23
  s_cmp_eq_u32 s30, 0
  s_cbranch_scc1 L_spun_8
  s_sub_u32 s30, s30, 1
  s_waitcnt lgkmcnt(0)
  v_readfirstlane_b32 s51, v22
  s_cmp_ge_u32 s51, 4
  s_cbranch_scc0 L_spin_7
L_spun_8:
  s_waitcnt lgkmcnt(0)
  v_mov_b32 v22, 384
  ds_read_b128 v[40:43], v22 offset:0
  ds_read_b128 v[44:47], v22 offset:16
  ds_read_b128 v[48:51], v22 offset:32
  ds_read_b128 v[52:55], v22 offset:48
  s_waitcnt lgkmcnt(0)
  v_max3_f32 v56, v40, v44, v48
  v_max3_f32 v57, v42, v46, v50
  v_max_f32 v56, v56, v52
  v_max_f32 v57, v57, v54
  v_sub_f32 v40, v40, v56
  v_sub_f32 v42, v42, v57
  v_sub_f32 v44, v44, v56
  v_sub_f32 v46, v46, v57
  v_sub_f32 v48, v48, v56
  v_sub_f32 v50, v50, v57
  v_sub_f32 v52, v52, v56
  v_sub_f32 v54, v54, v57
  v_mul_f32 v40, 0x3fb8aa3b, v40
  v_mul_f32 v42, 0x3fb8aa3b, v42
  v_mul_f32 v44, 0x3fb8aa3b, v44
  v_mul_f32 v46, 0x3fb8aa3b, v46
  v_mul_f32 v48, 0x3fb8aa3b, v48
  v_mul_f32 v50, 0x3fb8aa3b, v50
  v_mul_f32 v52, 0x3fb8aa3b, v52
  v_mul_f32 v54, 0x3fb8aa3b, v54
  v_exp_f32 v40, v40
  v_exp_f32 v42, v42
  v_exp_f32 v44, v44
  v_exp_f32 v46, v46
  v_exp_f32 v48, v48
  v_exp_f32 v50, v50
  v_exp_f32 v52, v52
  v_exp_f32 v54, v54
  v_sub_f32 v24, v24, v56
  v_sub_f32 v26, v26, v57
  v_mul_f32 v58, v40, v41
  v_mul_f32 v59, v42, v43
  v_mul_f32 v24, 0x3fb8aa3b, v24
  v_mul_f32 v26, 0x3fb8aa3b, v26
  v_fmac_f32 v58, v44, v45
  v_fmac_f32 v59, v46, v47
  v_fmac_f32 v58, v48, v49
  v_fmac_f32 v59, v50, v51
  v_fmac_f32 v58, v52, v53
  v_fmac_f32 v59, v54, v55
  v_exp_f32 v24, v24
  v_exp_f32 v26, v26
  s_mov_b32 s48, 0
  s_mov_b32 s49, -1
  s_mov_b32 s50, 0xc
  s_mov_b32 s51, 0
  v_cndmask_b32 v60, v24, v26, s[48:49]
  v_cndmask_b32 v64, v56, v57, s[50:51]
  v_cndmask_b32 v65, v58, v59, s[50:51]
  v_mov_b32 v72, s58
  v_mov_b32 v66, 0
  v_mov_b32 v67, 0
  v_lshlrev_b32 v68, 8, v0
  v_bfi_b32 v64, s31, v72, v64
  v_bfi_b32 v65, s31, v72, v65
  v_bfi_b32 v66, s31, v72, v66
  v_bfi_b32 v67, s31, v72, v67
  v_mov_b32 v69, 8
  v_mov_b32 v70, 1
  v_lshlrev_b32 v71, 4, v0
  v_mov_b32 v61, v60
  v_mfma_f32_16x16x32_bf16 v[16:19], v[8:11], v[136:139], v[16:19]
  v_mov_b32_dpp v20, v34 row_newbcast:10 row_mask:0xf bank_mask:0xf
  v_perm_b32 v8, v20, v20, v4
  v_perm_b32 v9, v20, v20, v5
  v_perm_b32 v10, v20, v20, v6
  v_perm_b32 v11, v20, v20, v7
  s_waitcnt vmcnt(6)
  v_mfma_f32_16x16x32_bf16 v[16:19], v[12:15], v[140:143], v[16:19]
  v_mov_b32_dpp v21, v34 row_newbcast:11 row_mask:0xf bank_mask:0xf
  v_perm_b32 v12, v21, v21, v4
  v_perm_b32 v13, v21, v21, v5
  v_perm_b32 v14, v21, v21, v6
  v_perm_b32 v15, v21, v21, v7
  s_waitcnt vmcnt(5)
  v_mfma_f32_16x16x32_bf16 v[16:19], v[8:11], v[144:147], v[16:19]
  v_mov_b32_dpp v20, v34 row_newbcast:12 row_mask:0xf bank_mask:0xf
  v_perm_b32 v8, v20, v20, v4
  v_perm_b32 v9, v20, v20, v5
  v_perm_b32 v10, v20, v20, v6
  v_perm_b32 v11, v20, v20, v7
  s_waitcnt vmcnt(4)
  v_mfma_f32_16x16x32_bf16 v[16:19], v[12:15], v[148:151], v[16:19]
  v_mov_b32_dpp v21, v34 row_newbcast:13 row_mask:0xf bank_mask:0xf
  v_perm_b32 v12, v21, v21, v4
  v_perm_b32 v13, v21, v21, v5
  v_perm_b32 v14, v21, v21, v6
  v_perm_b32 v15, v21, v21, v7
  s_waitcnt vmcnt(3)
  v_mfma_f32_16x16x32_bf16 v[16:19], v[8:11], v[152:155], v[16:19]
  v_mov_b32_dpp v20, v34 row_newbcast:14 row_mask:0xf bank_mask:0xf
  v_perm_b32 v8, v20, v20, v4
  v_perm_b32 v9, v20, v20, v5
  v_perm_b32 v10, v20, v20, v6
  v_perm_b32 v11, v20, v20, v7
  s_waitcnt vmcnt(2)
  v_mfma_f32_16x16x32_bf16 v[16:19], v[12:15], v[156:159], v[16:19]
  v_mov_b32_dpp v21, v34 row_newbcast:15 row_mask:0xf bank_mask:0xf
  v_perm_b32 v12, v21, v21, v4
  v_perm_b32 v13, v21, v21, v5
  v_perm_b32 v14, v21, v21, v6
  v_perm_b32 v15, v21, v21, v7
  s_waitcnt vmcnt(1)
  v_mfma_f32_16x16x32_bf16 v[16:19], v[8:11], v[160:163], v[16:19]
  s_waitcnt vmcnt(0)
  v_mfma_f32_16x16x32_bf16 v[16:19], v[12:15], v[164:167], v[16:19]
  s_nop 7
  v_pk_mul_f32 v[16:17], v[16:17], v[60:61]
  v_pk_mul_f32 v[18:19], v[18:19], v[60:61]
  ds_write_b128 v36, v[16:19]
  s_mov_b64 exec, 1
  s_waitcnt lgkmcnt(0)
  ds_add_rtn_u32 v70, v69, v70
  s_waitcnt lgkmcnt(0)
  v_readfirstlane_b32 s48, v70
  s_mov_b64 exec, -1
  s_cmp_eq_u32 s48, 3
  s_cbranch_scc0 L_A_done
  ds_read_b128 v[40:43], v71 offset:2560
  ds_read_b128 v[44:47], v71 offset:3584
  ds_read_b128 v[48:51], v71 offset:4608
  ds_read_b128 v[52:55], v71 offset:5632
  s_waitcnt lgkmcnt(2)
  v_pk_add_f32 v[40:41], v[40:41], v[44:45]
  v_pk_add_f32 v[42:43], v[42:43], v[46:47]
  s_waitcnt lgkmcnt(0)
  v_pk_add_f32 v[48:49], v[48:49], v[52:53]
  v_pk_add_f32 v[50:51], v[50:51], v[54:55]
  v_pk_add_f32 v[40:41], v[40:41], v[48:49]
  v_pk_add_f32 v[42:43], v[42:43], v[50:51]
  v_bfi_b32 v40, s31, v72, v40
  v_bfi_b32 v41, s31, v72, v41
  v_bfi_b32 v42, s31, v72, v42
  v_bfi_b32 v43, s31, v72, v43
  global_store_dwordx4 v37, v[40:43], s[52:53]
  s_mov_b64 exec, 0xf
  global_store_dwordx4 v68, v[64:67], s[54:55]
  s_mov_b64 exec, -1
  s_add_u32 s52, s52, 1179648
  s_addc_u32 s53, s53, 0
  s_add_u32 s54, s54, 1507328
  s_addc_u32 s55, s55, 0
  global_store_dwordx4 v37, v[40:43], s[52:53] sc1
  s_mov_b64 exec, 0xf
  global_store_dwordx4 v68, v[64:67], s[54:55] sc1
  s_mov_b64 exec, -1
  v_mov_b32 v39, 44
  v_mov_b32 v38, 1
  ds_write_b32 v39, v38
L_A_done:
  s_cmp_ge_u32 s29, 13
  s_cbranch_scc1 L_A_pf
  s_cmp_lt_u32 s29, 9
  s_cbranch_scc0 L_A_end
  s_add_u32 s3, s3, 4
  v_mov_b32 v39, 44
  s_nop 0
L_spin_9:
  ds_read_b32 v38, v39
  s_cmp_eq_u32 s30, 0
  s_cbranch_scc1 L_spun_10
  s_sub_u32 s30, s30, 1
  s_waitcnt lgkmcnt(0)
  v_readfirstlane_b32 s51, v38
  s_cmp_ge_u32 s51, 1
  s_cbranch_scc0 L_spin_9
L_spun_10:
  s_waitcnt lgkmcnt(0)
  s_nop 0
  s_branch L_FFN
L_A_pf:
  s_lshr_b32 s48, s28, 1
  s_sub_u32 s49, 3, s48
  s_and_b32 s49, s49, 7
  s_mul_i32 s50, s48, 9
  s_add_u32 s50, s50, s49
  s_lshl_b32 s50, s50, 7
  s_and_b32 s51, s28, 1
  s_mul_i32 s51, s51, 3
  s_add_u32 s51, s51, s29
  s_sub_u32 s51, s51, 13
  s_lshl_b32 s51, s51, 2
  s_add_u32 s51, s51, s3
  s_mul_i32 s51, s51, 24*9216
  s_add_u32 s50, s50, s51
  v_lshrrev_b32 v8, 3, v0
  v_mul_u32_u24 v8, 9216, v8
  v_and_b32 v9, 7, v0
  v_lshl_add_u32 v8, v9, 4, v8
  s_mov_b32 s32, s16
  s_mov_b32 s32, s16
  s_and_b32 s33, s17, 0xffff
  s_mov_b32 s34, 5308416
  s_mov_b32 s35, 0x20000
  s_mov_b32 s36, s18
  s_mov_b32 s36, s18
  s_and_b32 s37, s19, 0xffff
  s_mov_b32 s38, 5308416
  s_mov_b32 s39, 0x20000
  v_mov_b32 v39, 44
  s_nop 0
L_spin_11:
  ds_read_b32 v38, v39
  s_cmp_eq_u32 s30, 0
  s_cbranch_scc1 L_spun_12
  s_sub_u32 s30, s30, 1
  s_waitcnt lgkmcnt(0)
  v_readfirstlane_b32 s51, v38
  s_cmp_ge_u32 s51, 1
  s_cbranch_scc0 L_spin_11
L_spun_12:
  s_waitcnt lgkmcnt(0)
  s_add_u32 s51, s50, 0
  s_nop 0
  buffer_load_dwordx4 v[40:43], v8, s[32:35], s51 offen
  buffer_load_dwordx4 v[44:47], v8, s[36:39], s51 offen
  s_add_u32 s51, s50, 73728
  buffer_load_dwordx4 v[48:51], v8, s[32:35], s51 offen
  buffer_load_dwordx4 v[52:55], v8, s[36:39], s51 offen
  s_add_u32 s51, s50, 147456
  buffer_load_dwordx4 v[56:59], v8, s[32:35], s51 offen
  buffer_load_dwordx4 v[60:63], v8, s[36:39], s51 offen
  s_cmp_eq_u32 s48, 3
  s_cbranch_scc0 L_pf2_13
  s_add_u32 s50, s50, 8*128
  s_add_u32 s51, s50, 0
  buffer_load_dwordx4 v[40:43], v8, s[32:35], s51 offen
  buffer_load_dwordx4 v[44:47], v8, s[36:39], s51 offen
  s_add_u32 s51, s50, 73728
  buffer_load_dwordx4 v[48:51], v8, s[32:35], s51 offen
  buffer_load_dwordx4 v[52:55], v8, s[36:39], s51 offen
  s_add_u32 s51, s50, 147456
  buffer_load_dwordx4 v[56:59], v8, s[32:35], s51 offen
  buffer_load_dwordx4 v[60:63], v8, s[36:39], s51 offen
L_pf2_13:
L_A_end:
  s_endpgm
.p2align 6
L_C:
  s_setprio 3
  v_lshlrev_b32 v2, 2, v0
  v_mov_b32 v3, 0
  ds_write_b32 v2, v3
  s_and_b32 s28, s2, 7
  s_lshl_b32 s28, s28, 1
  s_bfe_u32 s29, s2, 0x10003
  s_add_u32 s28, s28, s29
  s_lshr_b32 s29, s2, 4
  s_mov_b32 s50, 0x3210CBA9
  s_mov_b32 s51, 0xFED87654
  s_lshl_b32 s29, s29, 2
  s_lshr_b64 s[50:51], s[50:51], s29
  s_and_b32 s29, s50, 15
  s_mov_b32 s30, 200000
  s_waitcnt lgkmcnt(0)
  s_barrier
  s_add_u32 s34, s26, 917504
  s_addc_u32 s35, s27, 0
  s_load_dword s56, s[34:35], 0
  v_lshlrev_b32 v1, 4, v0
  s_waitcnt lgkmcnt(0)
  s_add_u32 s56, s56, 1
  v_mov_b32 v40, s56
  v_mov_b32 v3, 48
  ds_write_b32 v3, v40
  s_waitcnt lgkmcnt(0)
  v_mov_b32 v3, 0
  v_mov_b32 v2, 1
  ds_write_b32 v3, v2
  s_getreg_b32 s61, hwreg(HW_REG_XCC_ID)
  s_and_b32 s61, s61, 15
  s_lshl_b32 s48, s28, 8
  s_add_u32 s48, s48, 1835008
  s_add_u32 s36, s26, s48
  s_addc_u32 s37, s27, 0
  v_mov_b32 v41, s61
  v_mov_b32 v42, v40
  v_mov_b32 v43, s61
  s_lshl_b32 s48, s29, 4
  v_mov_b32 v2, s48
  s_mov_b64 exec, 1
  global_store_dwordx4 v2, v[40:43], s[36:37] sc1
  s_mov_b64 exec, -1
  s_lshl_b32 s48, s28, 13
  s_add_u32 s48, s48, 1114112
  s_add_u32 s32, s26, s48
  s_addc_u32 s33, s27, 0
  s_add_u32 s34, s32, 4096
  s_addc_u32 s35, s33, 0
  v_mov_b32 v3, 40
  s_nop 0
L_spin_14:
  ds_read_b32 v2, v3
  s_cmp_eq_u32 s30, 0
  s_cbranch_scc1 L_spun_15
  s_sub_u32 s30, s30, 1
  s_waitcnt lgkmcnt(0)
  v_readfirstlane_b32 s51, v2
  s_cmp_ge_u32 s51, 1
  s_cbranch_scc0 L_spin_14
L_spun_15:
  s_waitcnt lgkmcnt(0)
  s_nop 0
L_poll_16:
  global_load_dwordx4 v[44:47], v1, s[32:33] offset:0 sc1
  global_load_dwordx4 v[48:51], v1, s[32:33] offset:1024 sc1
  global_load_dwordx4 v[52:55], v1, s[32:33] offset:2048 sc1
  global_load_dwordx4 v[56:59], v1, s[32:33] offset:3072 sc1
  global_load_dwordx4 v[60:63], v1, s[34:35] offset:0 sc1
  global_load_dwordx4 v[64:67], v1, s[34:35] offset:1024 sc1
  global_load_dwordx4 v[68:71], v1, s[34:35] offset:2048 sc1
  global_load_dwordx4 v[72:75], v1, s[34:35] offset:3072 sc1
  s_cmp_eq_u32 s30, 0
  s_cbranch_scc1 L_polled_17
  s_sub_u32 s30, s30, 1
  s_waitcnt vmcnt(0)
  v_xor_b32 v8, v46, v40
  v_bitop3_b32 v8, v8, v47, v40 bitop3:0xf6
  v_bitop3_b32 v8, v8, v50, v40 bitop3:0xf6
  v_bitop3_b32 v8, v8, v51, v40 bitop3:0xf6
  v_bitop3_b32 v8, v8, v54, v40 bitop3:0xf6
  v_bitop3_b32 v8, v8, v55, v40 bitop3:0xf6
  v_bitop3_b32 v8, v8, v58, v40 bitop3:0xf6
  v_bitop3_b32 v8, v8, v59, v40 bitop3:0xf6
  v_bitop3_b32 v8, v8, v62, v40 bitop3:0xf6
  v_bitop3_b32 v8, v8, v63, v40 bitop3:0xf6
  v_bitop3_b32 v8, v8, v66, v40 bitop3:0xf6
  v_bitop3_b32 v8, v8, v67, v40 bitop3:0xf6
  v_bitop3_b32 v8, v8, v70, v40 bitop3:0xf6
  v_bitop3_b32 v8, v8, v71, v40 bitop3:0xf6
  v_bitop3_b32 v8, v8, v74, v40 bitop3:0xf6
  v_bitop3_b32 v8, v8, v75, v40 bitop3:0xf6
  v_cmp_ne_u32 vcc, 0, v8
  s_cbranch_vccnz L_poll_16
L_polled_17:
  s_waitcnt vmcnt(0)
  v_pk_add_f32 v[16:17], v[44:45], v[52:53]
  v_pk_add_f32 v[20:21], v[60:61], v[68:69]
  v_pk_add_f32 v[18:19], v[48:49], v[56:57]
  v_pk_add_f32 v[22:23], v[64:65], v[72:73]
  v_pk_add_f32 v[16:17], v[16:17], v[20:21]
  v_pk_add_f32 v[18:19], v[18:19], v[22:23]
  v_cvt_pk_bf16_f32 v8, v16, v17
  v_cvt_pk_bf16_f32 v9, v18, v19
  v_lshlrev_b32 v2, 3, v0
  ds_write_b64 v2, v[8:9] offset:1792
  s_waitcnt lgkmcnt(0)
  v_mov_b32 v3, 4
  v_mov_b32 v2, 1
  ds_write_b32 v3, v2
  v_and_b32 v15, 0x3ff, v40
  s_cmp_ge_u32 s29, 13
  s_cbranch_scc1 L_C_done
  s_cmp_ge_u32 s29, 9
  s_cbranch_scc1 L_WO_C
  s_branch L_FFN_C
L_C_done:
  s_endpgm
.p2align 6
L_T:
  s_and_b32 s28, s2, 7
  s_lshl_b32 s28, s28, 1
  s_bfe_u32 s29, s2, 0x10003
  s_add_u32 s28, s28, s29
  s_lshr_b32 s29, s2, 4
  s_mov_b32 s50, 0x3210CBA9
  s_mov_b32 s51, 0xFED87654
  s_lshl_b32 s29, s29, 2
  s_lshr_b64 s[50:51], s[50:51], s29
  s_and_b32 s29, s50, 15
  s_mov_b32 s30, 200000
  s_cmp_eq_u32 s3, 1
  s_cselect_b32 s3, 8, s3
  s_sub_u32 s3, s3, 5
  s_waitcnt lgkmcnt(0)
  s_barrier
  v_and_b32 v8, 15, v0
  v_lshrrev_b32 v9, 3, v8
  v_mul_u32_u24 v9, 0x0202, v9
  v_add_u32 v9, 0x0100, v9
  v_lshlrev_b32 v10, 16, v9
  v_or_b32 v10, 0x0c0c, v10
  v_or_b32 v9, 0x0c0c0000, v9
  v_and_b32 v11, 1, v8
  v_cmp_eq_u32 vcc, 1, v11
  s_nop 1
  v_cndmask_b32 v9, v9, v10, vcc
  v_bfe_u32 v8, v8, 1, 2
  v_mov_b32 v11, 0x0c0c0c0c
  v_cmp_eq_u32 vcc, 0, v8
  s_nop 1
  v_cndmask_b32 v4, v11, v9, vcc
  v_cmp_eq_u32 vcc, 1, v8
  s_nop 1
  v_cndmask_b32 v5, v11, v9, vcc
  v_cmp_eq_u32 vcc, 2, v8
  s_nop 1
  v_cndmask_b32 v6, v11, v9, vcc
  v_cmp_eq_u32 vcc, 3, v8
  s_nop 1
  v_cndmask_b32 v7, v11, v9, vcc
L_Tail:
  s_setprio 0
  s_cmp_ge_u32 s29, 13
  s_cbranch_scc1 L_RED
  s_cmp_ge_u32 s29, 9
  s_cbranch_scc1 L_WO
  v_mov_b32 v9, 16
  s_nop 0
L_spin_18:
  ds_read_b32 v8, v9
  s_cmp_eq_u32 s30, 0
  s_cbranch_scc1 L_spun_19
  s_sub_u32 s30, s30, 1
  s_waitcnt lgkmcnt(0)
  v_readfirstlane_b32 s51, v8
  s_cmp_ge_u32 s51, 4
  s_cbranch_scc0 L_spin_18
L_spun_19:
  s_waitcnt lgkmcnt(0)
  s_nop 0
  s_branch L_FFN
.p2align 6
L_WO:
  v_lshrrev_b32 v8, 4, v0
  v_mul_u32_u24 v8, 1152, v8
  v_and_b32 v9, 15, v0
  v_lshl_add_u32 v1, v9, 4, v8
  s_lshl_b32 s48, s3, 8
  v_add_u32 v1, s48, v1
  v_lshrrev_b32 v8, 4, v0
  v_mul_u32_u24 v8, 1152, v8
  v_and_b32 v9, 15, v0
  v_lshl_add_u32 v2, v9, 4, v8
  v_add_u32 v2, 1024, v2
  v_cmp_gt_u32 vcc, 8, v9
  v_mov_b32 v8, 0x7fffffff
  s_nop 0
  v_cndmask_b32 v2, v8, v2, vcc
  s_lshl_b32 s48, s28, 2
  s_add_u32 s48, s48, s29
  s_sub_u32 s52, s48, 9
  s_mul_i32 s48, s52, 73728
  s_add_u32 s32, s12, s48
  s_addc_u32 s33, s13, 0
  s_and_b32 s33, s33, 0xffff
  s_mov_b32 s34, 73728
  s_mov_b32 s35, 0x20000
  v_and_b32 v8, 15, v0
  s_lshl_b32 s48, s3, 4
  v_add_u32 v8, s48, v8
  v_mul_u32_u24 v8, 2048, v8
  v_lshrrev_b32 v9, 4, v0
  v_lshl_add_u32 v8, v9, 4, v8
  s_lshl_b32 s48, s52, 5
  s_add_u32 s48, s48, 393216
  s_add_u32 s44, s26, s48
  s_addc_u32 s45, s27, 0
  v_mov_b32 v11, 0
  s_nop 0
L_spin_20:
  ds_read_b32 v10, v11
  s_cmp_eq_u32 s30, 0
  s_cbranch_scc1 L_spun_21
  s_sub_u32 s30, s30, 1
  s_waitcnt lgkmcnt(0)
  v_readfirstlane_b32 s51, v10
  s_cmp_ge_u32 s51, 1
  s_cbranch_scc0 L_spin_20
L_spun_21:
  s_waitcnt lgkmcnt(0)
  v_mov_b32 v10, 48
  ds_read_b32 v12, v10
  s_movk_i32 s31, 0x3ff
  s_waitcnt lgkmcnt(0)
  v_and_b32 v12, 0x3ff, v12
  v_mov_b32 v10, -1
  v_perm_b32 v16, v10, v10, v4
  v_perm_b32 v17, v10, v10, v5
  v_perm_b32 v18, v10, v10, v6
  v_perm_b32 v19, v10, v10, v7
  v_mov_b32 v4, v16
  v_mov_b32 v5, v17
  v_mov_b32 v6, v18
  v_mov_b32 v7, v19
  v_lshrrev_b32 v9, 4, v0
  v_lshlrev_b32 v9, 6, v9
  v_mov_b32 v11, 12
  s_nop 0
L_spin_22:
  ds_read_b32 v10, v11
  s_cmp_eq_u32 s30, 0
  s_cbranch_scc1 L_spun_23
  s_sub_u32 s30, s30, 1
  s_waitcnt lgkmcnt(0)
  v_readfirstlane_b32 s51, v10
  s_cmp_ge_u32 s51, 4
  s_cbranch_scc0 L_spin_22
L_spun_23:
  s_waitcnt lgkmcnt(0)
  s_cmp_eq_u32 s3, 0
  s_cbranch_scc1 L_wo0_24
  buffer_load_dwordx4 v[40:43], v1, s[32:35], 0 offen nt
  s_mov_b32 s48, 4608
  buffer_load_dwordx4 v[44:47], v1, s[32:35], s48 offen nt
  s_mov_b32 s48, 9216
  buffer_load_dwordx4 v[48:51], v1, s[32:35], s48 offen nt
  s_mov_b32 s48, 13824
  buffer_load_dwordx4 v[52:55], v1, s[32:35], s48 offen nt
  s_mov_b32 s48, 18432
  buffer_load_dwordx4 v[56:59], v1, s[32:35], s48 offen nt
  s_mov_b32 s48, 23040
  buffer_load_dwordx4 v[60:63], v1, s[32:35], s48 offen nt
  s_mov_b32 s48, 27648
  buffer_load_dwordx4 v[64:67], v1, s[32:35], s48 offen nt
  s_mov_b32 s48, 32256
  buffer_load_dwordx4 v[68:71], v1, s[32:35], s48 offen nt
  s_mov_b32 s48, 36864
  buffer_load_dwordx4 v[72:75], v1, s[32:35], s48 offen nt
  s_mov_b32 s48, 41472
  buffer_load_dwordx4 v[76:79], v1, s[32:35], s48 offen nt
  s_mov_b32 s48, 46080
  buffer_load_dwordx4 v[80:83], v1, s[32:35], s48 offen nt
  s_mov_b32 s48, 50688
  buffer_load_dwordx4 v[84:87], v1, s[32:35], s48 offen nt
  s_mov_b32 s48, 55296
  buffer_load_dwordx4 v[88:91], v1, s[32:35], s48 offen nt
  s_mov_b32 s48, 59904
  buffer_load_dwordx4 v[92:95], v1, s[32:35], s48 offen nt
  s_mov_b32 s48, 64512
  buffer_load_dwordx4 v[96:99], v1, s[32:35], s48 offen nt
  s_mov_b32 s48, 69120
  buffer_load_dwordx4 v[100:103], v1, s[32:35], s48 offen nt
  s_setprio 3
  s_waitcnt vmcnt(0)
  s_barrier
  ds_read_b128 v[32:35], v9 offset:128
  ds_read_b128 v[36:39], v9 offset:144
  s_waitcnt lgkmcnt(1)
  v_and_b32 v16, v32, v4
  v_and_b32 v17, v32, v5
  v_and_b32 v18, v32, v6
  v_and_b32 v19, v32, v7
  v_and_b32 v20, v33, v4
  v_and_b32 v21, v33, v5
  v_and_b32 v22, v33, v6
  v_and_b32 v23, v33, v7
  v_mfma_f32_16x16x32_bf16 v[24:27], v[16:19], v[40:43], 0
  v_and_b32 v16, v34, v4
  v_and_b32 v17, v34, v5
  v_and_b32 v18, v34, v6
  v_and_b32 v19, v34, v7
  v_mfma_f32_16x16x32_bf16 v[24:27], v[20:23], v[44:47], v[24:27]
  v_and_b32 v20, v35, v4
  v_and_b32 v21, v35, v5
  v_and_b32 v22, v35, v6
  v_and_b32 v23, v35, v7
  ds_read_b128 v[32:35], v9 offset:160
  v_mfma_f32_16x16x32_bf16 v[24:27], v[16:19], v[48:51], v[24:27]
  s_waitcnt lgkmcnt(1)
  v_and_b32 v16, v36, v4
  v_and_b32 v17, v36, v5
  v_and_b32 v18, v36, v6
  v_and_b32 v19, v36, v7
  v_mfma_f32_16x16x32_bf16 v[24:27], v[20:23], v[52:55], v[24:27]
  v_and_b32 v20, v37, v4
  v_and_b32 v21, v37, v5
  v_and_b32 v22, v37, v6
  v_and_b32 v23, v37, v7
  v_mfma_f32_16x16x32_bf16 v[24:27], v[16:19], v[56:59], v[24:27]
  v_and_b32 v16, v38, v4
  v_and_b32 v17, v38, v5
  v_and_b32 v18, v38, v6
  v_and_b32 v19, v38, v7
  v_mfma_f32_16x16x32_bf16 v[24:27], v[20:23], v[60:63], v[24:27]
  v_and_b32 v20, v39, v4
  v_and_b32 v21, v39, v5
  v_and_b32 v22, v39, v6
  v_and_b32 v23, v39, v7
  ds_read_b128 v[36:39], v9 offset:176
  v_mfma_f32_16x16x32_bf16 v[24:27], v[16:19], v[64:67], v[24:27]
  s_waitcnt lgkmcnt(1)
  v_and_b32 v16, v32, v4
  v_and_b32 v17, v32, v5
  v_and_b32 v18, v32, v6
  v_and_b32 v19, v32, v7
  v_mfma_f32_16x16x32_bf16 v[24:27], v[20:23], v[68:71], v[24:27]
  v_and_b32 v20, v33, v4
  v_and_b32 v21, v33, v5
  v_and_b32 v22, v33, v6
  v_and_b32 v23, v33, v7
  v_mfma_f32_16x16x32_bf16 v[24:27], v[16:19], v[72:75], v[24:27]
  v_and_b32 v16, v34, v4
  v_and_b32 v17, v34, v5
  v_and_b32 v18, v34, v6
  v_and_b32 v19, v34, v7
  v_mfma_f32_16x16x32_bf16 v[24:27], v[20:23], v[76:79], v[24:27]
  v_and_b32 v20, v35, v4
  v_and_b32 v21, v35, v5
  v_and_b32 v22, v35, v6
  v_and_b32 v23, v35, v7
  v_mfma_f32_16x16x32_bf16 v[24:27], v[16:19], v[80:83], v[24:27]
  s_waitcnt lgkmcnt(0)
  v_and_b32 v16, v36, v4
  v_and_b32 v17, v36, v5
  v_and_b32 v18, v36, v6
  v_and_b32 v19, v36, v7
  v_mfma_f32_16x16x32_bf16 v[24:27], v[20:23], v[84:87], v[24:27]
  v_and_b32 v20, v37, v4
  v_and_b32 v21, v37, v5
  v_and_b32 v22, v37, v6
  v_and_b32 v23, v37, v7
  v_mfma_f32_16x16x32_bf16 v[24:27], v[16:19], v[88:91], v[24:27]
  v_and_b32 v16, v38, v4
  v_and_b32 v17, v38, v5
  v_and_b32 v18, v38, v6
  v_and_b32 v19, v38, v7
  v_mfma_f32_16x16x32_bf16 v[24:27], v[20:23], v[92:95], v[24:27]
  v_and_b32 v20, v39, v4
  v_and_b32 v21, v39, v5
  v_and_b32 v22, v39, v6
  v_and_b32 v23, v39, v7
  v_mfma_f32_16x16x32_bf16 v[24:27], v[16:19], v[96:99], v[24:27]
  s_nop 0
  v_mfma_f32_16x16x32_bf16 v[24:27], v[20:23], v[100:103], v[24:27]
  s_mov_b32 exec_hi, 0
  s_nop 6
  v_bfi_b32 v24, s31, v12, v24
  v_bfi_b32 v25, s31, v12, v25
  v_bfi_b32 v26, s31, v12, v26
  v_bfi_b32 v27, s31, v12, v27
  global_store_dwordx4 v8, v[24:27], s[44:45] sc1
  s_mov_b32 exec_hi, -1
  s_endpgm
L_wo0_24:
  buffer_load_dwordx4 v[40:43], v1, s[32:35], 0 offen nt
  buffer_load_dwordx4 v[104:107], v2, s[32:35], 0 offen nt
  s_mov_b32 s48, 4608
  buffer_load_dwordx4 v[44:47], v1, s[32:35], s48 offen nt
  buffer_load_dwordx4 v[108:111], v2, s[32:35], s48 offen nt
  s_mov_b32 s48, 9216
  buffer_load_dwordx4 v[48:51], v1, s[32:35], s48 offen nt
  buffer_load_dwordx4 v[112:115], v2, s[32:35], s48 offen nt
  s_mov_b32 s48, 13824
  buffer_load_dwordx4 v[52:55], v1, s[32:35], s48 offen nt
  buffer_load_dwordx4 v[116:119], v2, s[32:35], s48 offen nt
  s_mov_b32 s48, 18432
  buffer_load_dwordx4 v[56:59], v1, s[32:35], s48 offen nt
  buffer_load_dwordx4 v[120:123], v2, s[32:35], s48 offen nt
  s_mov_b32 s48, 23040
  buffer_load_dwordx4 v[60:63], v1, s[32:35], s48 offen nt
  buffer_load_dwordx4 v[124:127], v2, s[32:35], s48 offen nt
  s_mov_b32 s48, 27648
  buffer_load_dwordx4 v[64:67], v1, s[32:35], s48 offen nt
  buffer_load_dwordx4 v[128:131], v2, s[32:35], s48 offen nt
  s_mov_b32 s48, 32256
  buffer_load_dwordx4 v[68:71], v1, s[32:35], s48 offen nt
  buffer_load_dwordx4 v[132:135], v2, s[32:35], s48 offen nt
  s_mov_b32 s48, 36864
  buffer_load_dwordx4 v[72:75], v1, s[32:35], s48 offen nt
  buffer_load_dwordx4 v[136:139], v2, s[32:35], s48 offen nt
  s_mov_b32 s48, 41472
  buffer_load_dwordx4 v[76:79], v1, s[32:35], s48 offen nt
  buffer_load_dwordx4 v[140:143], v2, s[32:35], s48 offen nt
  s_mov_b32 s48, 46080
  buffer_load_dwordx4 v[80:83], v1, s[32:35], s48 offen nt
  buffer_load_dwordx4 v[144:147], v2, s[32:35], s48 offen nt
  s_mov_b32 s48, 50688
  buffer_load_dwordx4 v[84:87], v1, s[32:35], s48 offen nt
  buffer_load_dwordx4 v[148:151], v2, s[32:35], s48 offen nt
  s_mov_b32 s48, 55296
  buffer_load_dwordx4 v[88:91], v1, s[32:35], s48 offen nt
  buffer_load_dwordx4 v[152:155], v2, s[32:35], s48 offen nt
  s_mov_b32 s48, 59904
  buffer_load_dwordx4 v[92:95], v1, s[32:35], s48 offen nt
  buffer_load_dwordx4 v[156:159], v2, s[32:35], s48 offen nt
  s_mov_b32 s48, 64512
  buffer_load_dwordx4 v[96:99], v1, s[32:35], s48 offen nt
  buffer_load_dwordx4 v[160:163], v2, s[32:35], s48 offen nt
  s_mov_b32 s48, 69120
  buffer_load_dwordx4 v[100:103], v1, s[32:35], s48 offen nt
  buffer_load_dwordx4 v[164:167], v2, s[32:35], s48 offen nt
  s_setprio 3
  s_waitcnt vmcnt(0)
  s_barrier
  ds_read_b128 v[32:35], v9 offset:128
  ds_read_b128 v[36:39], v9 offset:144
  s_waitcnt lgkmcnt(1)
  v_and_b32 v16, v32, v4
  v_and_b32 v17, v32, v5
  v_and_b32 v18, v32, v6
  v_and_b32 v19, v32, v7
  v_and_b32 v20, v33, v4
  v_and_b32 v21, v33, v5
  v_and_b32 v22, v33, v6
  v_and_b32 v23, v33, v7
  v_mfma_f32_16x16x32_bf16 v[24:27], v[16:19], v[40:43], 0
  v_mfma_f32_16x16x32_bf16 v[28:31], v[16:19], v[104:107], 0
  v_and_b32 v16, v34, v4
  v_and_b32 v17, v34, v5
  v_and_b32 v18, v34, v6
  v_and_b32 v19, v34, v7
  v_mfma_f32_16x16x32_bf16 v[24:27], v[20:23], v[44:47], v[24:27]
  v_mfma_f32_16x16x32_bf16 v[28:31], v[20:23], v[108:111], v[28:31]
  v_and_b32 v20, v35, v4
  v_and_b32 v21, v35, v5
  v_and_b32 v22, v35, v6
  v_and_b32 v23, v35, v7
  ds_read_b128 v[32:35], v9 offset:160
  v_mfma_f32_16x16x32_bf16 v[24:27], v[16:19], v[48:51], v[24:27]
  v_mfma_f32_16x16x32_bf16 v[28:31], v[16:19], v[112:115], v[28:31]
  s_waitcnt lgkmcnt(1)
  v_and_b32 v16, v36, v4
  v_and_b32 v17, v36, v5
  v_and_b32 v18, v36, v6
  v_and_b32 v19, v36, v7
  v_mfma_f32_16x16x32_bf16 v[24:27], v[20:23], v[52:55], v[24:27]
  v_mfma_f32_16x16x32_bf16 v[28:31], v[20:23], v[116:119], v[28:31]
  v_and_b32 v20, v37, v4
  v_and_b32 v21, v37, v5
  v_and_b32 v22, v37, v6
  v_and_b32 v23, v37, v7
  v_mfma_f32_16x16x32_bf16 v[24:27], v[16:19], v[56:59], v[24:27]
  v_mfma_f32_16x16x32_bf16 v[28:31], v[16:19], v[120:123], v[28:31]
  v_and_b32 v16, v38, v4
  v_and_b32 v17, v38, v5
  v_and_b32 v18, v38, v6
  v_and_b32 v19, v38, v7
  v_mfma_f32_16x16x32_bf16 v[24:27], v[20:23], v[60:63], v[24:27]
  v_mfma_f32_16x16x32_bf16 v[28:31], v[20:23], v[124:127], v[28:31]
  v_and_b32 v20, v39, v4
  v_and_b32 v21, v39, v5
  v_and_b32 v22, v39, v6
  v_and_b32 v23, v39, v7
  ds_read_b128 v[36:39], v9 offset:176
  v_mfma_f32_16x16x32_bf16 v[24:27], v[16:19], v[64:67], v[24:27]
  v_mfma_f32_16x16x32_bf16 v[28:31], v[16:19], v[128:131], v[28:31]
  s_waitcnt lgkmcnt(1)
  v_and_b32 v16, v32, v4
  v_and_b32 v17, v32, v5
  v_and_b32 v18, v32, v6
  v_and_b32 v19, v32, v7
  v_mfma_f32_16x16x32_bf16 v[24:27], v[20:23], v[68:71], v[24:27]
  v_mfma_f32_16x16x32_bf16 v[28:31], v[20:23], v[132:135], v[28:31]
  v_and_b32 v20, v33, v4
  v_and_b32 v21, v33, v5
  v_and_b32 v22, v33, v6
  v_and_b32 v23, v33, v7
  v_mfma_f32_16x16x32_bf16 v[24:27], v[16:19], v[72:75], v[24:27]
  v_mfma_f32_16x16x32_bf16 v[28:31], v[16:19], v[136:139], v[28:31]
  v_and_b32 v16, v34, v4
  v_and_b32 v17, v34, v5
  v_and_b32 v18, v34, v6
  v_and_b32 v19, v34, v7
  v_mfma_f32_16x16x32_bf16 v[24:27], v[20:23], v[76:79], v[24:27]
  v_mfma_f32_16x16x32_bf16 v[28:31], v[20:23], v[140:143], v[28:31]
  v_and_b32 v20, v35, v4
  v_and_b32 v21, v35, v5
  v_and_b32 v22, v35, v6
  v_and_b32 v23, v35, v7
  v_mfma_f32_16x16x32_bf16 v[24:27], v[16:19], v[80:83], v[24:27]
  v_mfma_f32_16x16x32_bf16 v[28:31], v[16:19], v[144:147], v[28:31]
  s_waitcnt lgkmcnt(0)
  v_and_b32 v16, v36, v4
  v_and_b32 v17, v36, v5
  v_and_b32 v18, v36, v6
  v_and_b32 v19, v36, v7
  v_mfma_f32_16x16x32_bf16 v[24:27], v[20:23], v[84:87], v[24:27]
  v_mfma_f32_16x16x32_bf16 v[28:31], v[20:23], v[148:151], v[28:31]
  v_and_b32 v20, v37, v4
  v_and_b32 v21, v37, v5
  v_and_b32 v22, v37, v6
  v_and_b32 v23, v37, v7
  v_mfma_f32_16x16x32_bf16 v[24:27], v[16:19], v[88:91], v[24:27]
  v_mfma_f32_16x16x32_bf16 v[28:31], v[16:19], v[152:155], v[28:31]
  v_and_b32 v16, v38, v4
  v_and_b32 v17, v38, v5
  v_and_b32 v18, v38, v6
  v_and_b32 v19, v38, v7
  v_mfma_f32_16x16x32_bf16 v[24:27], v[20:23], v[92:95], v[24:27]
  v_mfma_f32_16x16x32_bf16 v[28:31], v[20:23], v[156:159], v[28:31]
  v_and_b32 v20, v39, v4
  v_and_b32 v21, v39, v5
  v_and_b32 v22, v39, v6
  v_and_b32 v23, v39, v7
  v_mfma_f32_16x16x32_bf16 v[24:27], v[16:19], v[96:99], v[24:27]
  v_mfma_f32_16x16x32_bf16 v[28:31], v[16:19], v[160:163], v[28:31]
  v_mfma_f32_16x16x32_bf16 v[24:27], v[20:23], v[100:103], v[24:27]
  v_mfma_f32_16x16x32_bf16 v[28:31], v[20:23], v[164:167], v[28:31]
  s_mov_b32 exec_hi, 0
  s_nop 5
  v_bfi_b32 v24, s31, v12, v24
  v_bfi_b32 v25, s31, v12, v25
  v_bfi_b32 v26, s31, v12, v26
  v_bfi_b32 v27, s31, v12, v27
  global_store_dwordx4 v8, v[24:27], s[44:45] sc1
  s_mov_b32 exec_hi, -1
  s_mov_b32 exec_lo, 0x00ff00ff
  s_mov_b32 exec_hi, 0
  s_add_u32 s44, s44, 131072
  s_addc_u32 s45, s45, 0
  v_bfi_b32 v28, s31, v12, v28
  v_bfi_b32 v29, s31, v12, v29
  v_bfi_b32 v30, s31, v12, v30
  v_bfi_b32 v31, s31, v12, v31
  global_store_dwordx4 v8, v[28:31], s[44:45] sc1
  s_mov_b64 exec, -1
  s_endpgm
.p2align 6
L_WO_C:
  s_lshl_b32 s48, s28, 2
  s_add_u32 s48, s48, s29
  s_sub_u32 s52, s48, 9
  s_add_u32 s53, s52, 48
  s_min_u32 s50, s53, 71
  v_lshrrev_b32 v8, 4, v0
  v_and_b32 v9, 1, v0
  v_lshl_add_u32 v9, v9, 2, v8
  v_lshlrev_b32 v9, 1, v9
  s_lshl_b32 s48, s50, 4
  v_add_u32 v121, s48, v9
  global_load_ushort v120, v121, s[4:5]
  s_lshl_b32 s48, s50, 11
  s_add_u32 s48, s48, 393216
  s_add_u32 s40, s26, s48
  s_addc_u32 s41, s27, 0
  s_mul_i32 s48, s50, 4608
  s_add_u32 s48, s48, 540672
  s_add_u32 s42, s26, s48
  s_addc_u32 s43, s27, 0
  s_add_u32 s44, s42, 4096
  s_addc_u32 s45, s43, 0
  v_lshlrev_b32 v1, 4, v0
  v_lshrrev_b32 v8, 1, v0
  v_mul_u32_u24 v8, 2304, v8
  v_and_b32 v9, 1, v0
  v_lshl_add_u32 v122, v9, 4, v8
  s_lshl_b32 s48, s50, 5
  s_add_u32 s48, s48, 1900544
  s_add_u32 s46, s26, s48
  s_addc_u32 s47, s27, 0
  v_mov_b32 v9, 0
  s_nop 0
L_spin_25:
  ds_read_b32 v8, v9
  s_cmp_eq_u32 s30, 0
  s_cbranch_scc1 L_spun_26
  s_sub_u32 s30, s30, 1
  s_waitcnt lgkmcnt(0)
  v_readfirstlane_b32 s51, v8
  s_cmp_ge_u32 s51, 1
  s_cbranch_scc0 L_spin_25
L_spun_26:
  s_waitcnt lgkmcnt(0)
  v_mov_b32 v8, 48
  ds_read_b32 v123, v8
  s_movk_i32 s31, 0x3ff
  s_waitcnt lgkmcnt(0)
  v_and_b32 v123, 0x3ff, v123
  v_mov_b32 v96, v123
  v_mov_b32 v97, v123
  v_mov_b32 v98, v123
  v_mov_b32 v99, v123
  s_mov_b32 s62, 0
  s_lshl_b32 s48, s28, 8
  s_add_u32 s48, s48, 1835008
  s_add_u32 s36, s26, s48
  s_addc_u32 s37, s27, 0
  s_mov_b64 exec, 0xffff
L_xp_27:
  global_load_dwordx4 v[16:19], v1, s[36:37] sc1
  s_cmp_eq_u32 s30, 0
  s_cbranch_scc1 L_xpd_28
  s_sub_u32 s30, s30, 1
  s_waitcnt vmcnt(0)
  v_xor_b32 v8, v16, v40
  v_bitop3_b32 v8, v8, v18, v40 bitop3:0xf6
  v_cmp_ne_u32 vcc, 0, v8
  s_cbranch_vccnz L_xp_27
L_xpd_28:
  s_waitcnt vmcnt(0)
  v_cmp_ne_u32 vcc, s61, v17
  s_cmp_eq_u64 vcc, 0
  s_cselect_b32 s62, 1, 0
  s_mov_b64 exec, -1
  s_mov_b32 s48, 131072
  s_mov_b32 s49, 1310720
  s_cmp_eq_u32 s62, 1
  s_cselect_b32 s49, s48, s49
  s_lshl_b32 s48, s52, 12
  s_add_u32 s48, s48, s49
  s_add_u32 s36, s26, s48
  s_addc_u32 s37, s27, 0
  s_mov_b32 s48, 65536
  s_mov_b32 s49, 1572864
  s_cmp_eq_u32 s62, 1
  s_cselect_b32 s49, s48, s49
  s_lshl_b32 s48, s52, 8
  s_add_u32 s48, s48, s49
  s_add_u32 s38, s26, s48
  s_addc_u32 s39, s27, 0
  v_and_b32 v3, 3, v0
  v_lshlrev_b32 v3, 2, v3
  v_lshrrev_b32 v9, 4, v0
  v_add_u32 v3, v3, v9
  v_lshlrev_b32 v3, 4, v3
  v_lshlrev_b32 v12, 2, v0
  v_mov_b32 v11, 44
  s_nop 0
L_spin_29:
  ds_read_b32 v10, v11
  s_cmp_eq_u32 s30, 0
  s_cbranch_scc1 L_spun_30
  s_sub_u32 s30, s30, 1
  s_waitcnt lgkmcnt(0)
  v_readfirstlane_b32 s51, v10
  s_cmp_ge_u32 s51, 1
  s_cbranch_scc0 L_spin_29
L_spun_30:
  s_waitcnt lgkmcnt(0)
  s_waitcnt vmcnt(0)
  v_lshlrev_b32 v120, 16, v120
  s_mov_b32 s57, 48
L_poll_31:
  s_sub_u32 s57, s57, 1
  s_cbranch_scc0 L_keep_33
  s_mov_b32 s48, 131072
  s_mov_b32 s49, 1310720
  s_cmp_eq_u32 0, 1
  s_cselect_b32 s49, s48, s49
  s_lshl_b32 s48, s52, 12
  s_add_u32 s48, s48, s49
  s_add_u32 s36, s26, s48
  s_addc_u32 s37, s27, 0
  s_mov_b32 s48, 65536
  s_mov_b32 s49, 1572864
  s_cmp_eq_u32 0, 1
  s_cselect_b32 s49, s48, s49
  s_lshl_b32 s48, s52, 8
  s_add_u32 s48, s48, s49
  s_add_u32 s38, s26, s48
  s_addc_u32 s39, s27, 0
  s_mov_b32 s57, 0x7fffffff
L_keep_33:
  global_load_dwordx4 v[44:47], v1, s[36:37] offset:0 sc1
  global_load_dwordx4 v[48:51], v1, s[36:37] offset:1024 sc1
  global_load_dwordx4 v[52:55], v1, s[36:37] offset:2048 sc1
  global_load_dwordx4 v[56:59], v1, s[36:37] offset:3072 sc1
  global_load_dwordx4 v[60:63], v3, s[38:39] sc1
  s_cmp_eq_u32 s30, 0
  s_cbranch_scc1 L_polled_32
  s_sub_u32 s30, s30, 1
  s_waitcnt vmcnt(0)
  v_xor_b32 v16, v44, v15
  v_xor_b32 v17, v45, v15
  v_xor_b32 v18, v46, v15
  v_xor_b32 v19, v47, v15
  v_xor_b32 v20, v48, v15
  v_xor_b32 v21, v49, v15
  v_xor_b32 v22, v50, v15
  v_xor_b32 v23, v51, v15
  v_xor_b32 v24, v52, v15
  v_xor_b32 v25, v53, v15
  v_xor_b32 v26, v54, v15
  v_xor_b32 v27, v55, v15
  v_xor_b32 v28, v56, v15
  v_xor_b32 v29, v57, v15
  v_xor_b32 v30, v58, v15
  v_xor_b32 v31, v59, v15
  v_xor_b32 v32, v60, v15
  v_xor_b32 v33, v61, v15
  v_xor_b32 v34, v62, v15
  v_xor_b32 v35, v63, v15
  v_or3_b32 v10, v16, v17, v18
  v_or3_b32 v10, v10, v19, v20
  v_or3_b32 v10, v10, v21, v22
  v_or3_b32 v10, v10, v23, v24
  v_or3_b32 v10, v10, v25, v26
  v_or3_b32 v10, v10, v27, v28
  v_or3_b32 v10, v10, v29, v30
  v_or3_b32 v10, v10, v31, v32
  v_or3_b32 v10, v10, v33, v34
  v_or_b32 v10, v10, v35
  v_and_b32 v10, 0x3ff, v10
  v_cmp_ne_u32 vcc, 0, v10
  s_cbranch_vccnz L_poll_31
L_polled_32:
  v_max_f32_dpp v36, v32, v32 quad_perm:[1,0,3,2] row_mask:0xf bank_mask:0xf
  s_nop 1
  v_max_f32_dpp v36, v36, v36 quad_perm:[2,3,0,1] row_mask:0xf bank_mask:0xf
  v_mov_b32 v37, v36
  s_nop 1
  v_permlane16_swap_b32 v36, v37
  v_max_f32 v36, v36, v37
  v_mov_b32 v37, v36
  s_nop 1
  v_permlane32_swap_b32 v36, v37
  v_max_f32 v36, v36, v37
  v_sub_f32 v32, v32, v36
  v_mul_f32 v32, 0x3fb8aa3b, v32
  v_exp_f32 v32, v32
  s_nop 0
  v_mul_f32 v33, v33, v32
  v_mul_f32_dpp v16, v32, v16 quad_perm:[0,0,0,0] row_mask:0xf bank_mask:0xf
  v_mul_f32_dpp v17, v32, v17 quad_perm:[0,0,0,0] row_mask:0xf bank_mask:0xf
  v_mul_f32_dpp v18, v32, v18 quad_perm:[0,0,0,0] row_mask:0xf bank_mask:0xf
  v_mul_f32_dpp v19, v32, v19 quad_perm:[0,0,0,0] row_mask:0xf bank_mask:0xf
  v_add_f32_dpp v33, v33, v33 quad_perm:[1,0,3,2] row_mask:0xf bank_mask:0xf
  v_fmac_f32_dpp v16, v32, v20 quad_perm:[1,1,1,1] row_mask:0xf bank_mask:0xf
  v_fmac_f32_dpp v17, v32, v21 quad_perm:[1,1,1,1] row_mask:0xf bank_mask:0xf
  v_fmac_f32_dpp v18, v32, v22 quad_perm:[1,1,1,1] row_mask:0xf bank_mask:0xf
  v_fmac_f32_dpp v19, v32, v23 quad_perm:[1,1,1,1] row_mask:0xf bank_mask:0xf
  v_add_f32_dpp v33, v33, v33 quad_perm:[2,3,0,1] row_mask:0xf bank_mask:0xf
  v_fmac_f32_dpp v16, v32, v24 quad_perm:[2,2,2,2] row_mask:0xf bank_mask:0xf
  v_fmac_f32_dpp v17, v32, v25 quad_perm:[2,2,2,2] row_mask:0xf bank_mask:0xf
  v_fmac_f32_dpp v18, v32, v26 quad_perm:[2,2,2,2] row_mask:0xf bank_mask:0xf
  v_fmac_f32_dpp v19, v32, v27 quad_perm:[2,2,2,2] row_mask:0xf bank_mask:0xf
  v_mov_b32 v37, v33
  v_fmac_f32_dpp v16, v32, v28 quad_perm:[3,3,3,3] row_mask:0xf bank_mask:0xf
  v_fmac_f32_dpp v17, v32, v29 quad_perm:[3,3,3,3] row_mask:0xf bank_mask:0xf
  v_fmac_f32_dpp v18, v32, v30 quad_perm:[3,3,3,3] row_mask:0xf bank_mask:0xf
  v_fmac_f32_dpp v19, v32, v31 quad_perm:[3,3,3,3] row_mask:0xf bank_mask:0xf
  v_permlane16_swap_b32 v33, v37
  v_add_f32 v33, v33, v37
  v_permlane32_swap_b32 v16, v18
  v_permlane32_swap_b32 v17, v19
  v_mov_b32 v37, v33
  v_pk_add_f32 v[16:17], v[16:17], v[18:19]
  s_nop 0
  v_permlane32_swap_b32 v33, v37
  v_permlane16_swap_b32 v16, v17
  v_add_f32 v33, v33, v37
  v_add_f32 v16, v16, v17
  v_rcp_f32 v33, v33
  s_nop 0
  v_mul_f32 v16, v16, v33
  v_cvt_pk_bf16_f32 v16, v16, v16
  ds_write_b32 v12, v16 offset:128
  s_waitcnt lgkmcnt(0)
  s_barrier
  s_cmp_lt_u32 s53, 72
  s_cbranch_scc1 L_RED_main
  s_endpgm
.p2align 6
L_RED:
  s_cmp_ge_u32 s3, 1
  s_cbranch_scc1 L_RED_done
  s_mul_i32 s53, s28, 3
  s_add_u32 s53, s53, s29
  s_sub_u32 s53, s53, 13
  s_min_u32 s50, s53, 71
  v_lshrrev_b32 v8, 4, v0
  v_and_b32 v9, 1, v0
  v_lshl_add_u32 v9, v9, 2, v8
  v_lshlrev_b32 v9, 1, v9
  s_lshl_b32 s48, s50, 4
  v_add_u32 v121, s48, v9
  global_load_ushort v120, v121, s[4:5]
  s_lshl_b32 s48, s50, 11
  s_add_u32 s48, s48, 393216
  s_add_u32 s40, s26, s48
  s_addc_u32 s41, s27, 0
  s_mul_i32 s48, s50, 4608
  s_add_u32 s48, s48, 540672
  s_add_u32 s42, s26, s48
  s_addc_u32 s43, s27, 0
  s_add_u32 s44, s42, 4096
  s_addc_u32 s45, s43, 0
  v_lshlrev_b32 v1, 4, v0
  v_lshrrev_b32 v8, 1, v0
  v_mul_u32_u24 v8, 2304, v8
  v_and_b32 v9, 1, v0
  v_lshl_add_u32 v122, v9, 4, v8
  s_lshl_b32 s48, s50, 5
  s_add_u32 s48, s48, 1900544
  s_add_u32 s46, s26, s48
  s_addc_u32 s47, s27, 0
  v_mov_b32 v9, 0
  s_nop 0
L_spin_34:
  ds_read_b32 v8, v9
  s_cmp_eq_u32 s30, 0
  s_cbranch_scc1 L_spun_35
  s_sub_u32 s30, s30, 1
  s_waitcnt lgkmcnt(0)
  v_readfirstlane_b32 s51, v8
  s_cmp_ge_u32 s51, 1
  s_cbranch_scc0 L_spin_34
L_spun_35:
  s_waitcnt lgkmcnt(0)
  v_mov_b32 v8, 48
  ds_read_b32 v123, v8
  s_movk_i32 s31, 0x3ff
  s_waitcnt lgkmcnt(0)
  v_and_b32 v123, 0x3ff, v123
  v_mov_b32 v96, v123
  v_mov_b32 v97, v123
  v_mov_b32 v98, v123
  v_mov_b32 v99, v123
  v_mov_b32 v13, 44
  s_nop 0
L_spin_36:
  ds_read_b32 v12, v13
  s_cmp_eq_u32 s30, 0
  s_cbranch_scc1 L_spun_37
  s_sub_u32 s30, s30, 1
  s_waitcnt lgkmcnt(0)
  v_readfirstlane_b32 s51, v12
  s_cmp_ge_u32 s51, 1
  s_cbranch_scc0 L_spin_36
L_spun_37:
  s_waitcnt lgkmcnt(0)
  s_waitcnt vmcnt(0)
  v_lshlrev_b32 v120, 16, v120
  s_setprio 3
L_RED_main:
L_poll_38:
  global_load_dwordx4 v[60:63], v1, s[40:41] offset:0 sc1
  global_load_dwordx4 v[64:67], v1, s[40:41] offset:1024 sc1
  s_cmp_eq_u32 s30, 0
  s_cbranch_scc1 L_polled_39
  s_sub_u32 s30, s30, 1
  s_waitcnt vmcnt(0)
  v_xor_b32 v16, v60, v123
  v_xor_b32 v17, v61, v123
  v_xor_b32 v18, v62, v123
  v_xor_b32 v19, v63, v123
  v_xor_b32 v20, v64, v123
  v_xor_b32 v21, v65, v123
  v_xor_b32 v22, v66, v123
  v_xor_b32 v23, v67, v123
  v_or3_b32 v12, v16, v17, v18
  v_or3_b32 v12, v12, v19, v20
  v_or3_b32 v12, v12, v21, v22
  v_or_b32 v12, v12, v23
  v_and_b32 v12, 0x3ff, v12
  v_cmp_ne_u32 vcc, 0, v12
  s_cbranch_vccnz L_poll_38
L_polled_39:
  v_pk_add_f32 v[16:17], v[16:17], v[20:21]
  v_pk_add_f32 v[18:19], v[18:19], v[22:23]
  s_nop 1
  v_permlane32_swap_b32 v16, v18
  v_permlane32_swap_b32 v17, v19
  v_pk_add_f32 v[16:17], v[16:17], v[18:19]
  s_nop 1
  v_permlane16_swap_b32 v16, v17
  v_add_f32 v16, v16, v17
  s_nop 1
  v_add_f32_dpp v16, v16, v16 row_ror:2 row_mask:0xf bank_mask:0xf
  s_nop 1
  v_add_f32_dpp v16, v16, v16 row_ror:4 row_mask:0xf bank_mask:0xf
  s_nop 1
  v_add_f32_dpp v16, v16, v16 row_ror:8 row_mask:0xf bank_mask:0xf
  v_cvt_pk_bf16_f32 v12, v16, v16
  v_lshlrev_b32 v16, 16, v12
  v_add_f32 v120, v120, v16
  v_cvt_pk_bf16_f32 v12, v120, v120
  v_lshlrev_b32 v120, 16, v12
  v_mov_b32 v20, v120
  v_mov_b32 v21, v120
  s_nop 1
  v_permlane16_swap_b32 v20, v21
  v_mov_b32 v22, v20
  v_mov_b32 v23, v21
  s_nop 0
  v_permlane32_swap_b32 v20, v22
  v_permlane32_swap_b32 v21, v23
  v_bfi_b32 v20, s31, v123, v20
  v_bfi_b32 v21, s31, v123, v21
  v_bfi_b32 v22, s31, v123, v22
  v_bfi_b32 v23, s31, v123, v23
  global_store_dwordx4 v122, v[20:23], s[46:47] sc1
  s_nop 0
L_poll_40:
  global_load_dwordx4 v[80:83], v1, s[42:43] offset:0 sc1
  global_load_dwordx4 v[84:87], v1, s[42:43] offset:1024 sc1
  global_load_dwordx4 v[88:91], v1, s[42:43] offset:2048 sc1
  global_load_dwordx4 v[92:95], v1, s[42:43] offset:3072 sc1
  s_mov_b32 exec_hi, 0
  global_load_dwordx4 v[96:99], v1, s[44:45] sc1
  s_mov_b32 exec_hi, -1
  s_cmp_eq_u32 s30, 0
  s_cbranch_scc1 L_polled_41
  s_sub_u32 s30, s30, 1
  s_waitcnt vmcnt(0)
  v_xor_b32 v16, v80, v123
  v_xor_b32 v17, v81, v123
  v_xor_b32 v18, v82, v123
  v_xor_b32 v19, v83, v123
  v_xor_b32 v20, v84, v123
  v_xor_b32 v21, v85, v123
  v_xor_b32 v22, v86, v123
  v_xor_b32 v23, v87, v123
  v_xor_b32 v24, v88, v123
  v_xor_b32 v25, v89, v123
  v_xor_b32 v26, v90, v123
  v_xor_b32 v27, v91, v123
  v_xor_b32 v28, v92, v123
  v_xor_b32 v29, v93, v123
  v_xor_b32 v30, v94, v123
  v_xor_b32 v31, v95, v123
  v_xor_b32 v32, v96, v123
  v_xor_b32 v33, v97, v123
  v_xor_b32 v34, v98, v123
  v_xor_b32 v35, v99, v123
  v_or3_b32 v12, v16, v17, v18
  v_or3_b32 v12, v12, v19, v20
  v_or3_b32 v12, v12, v21, v22
  v_or3_b32 v12, v12, v23, v24
  v_or3_b32 v12, v12, v25, v26
  v_or3_b32 v12, v12, v27, v28
  v_or3_b32 v12, v12, v29, v30
  v_or3_b32 v12, v12, v31, v32
  v_or3_b32 v12, v12, v33, v34
  v_or_b32 v12, v12, v35
  v_and_b32 v12, 0x3ff, v12
  v_cmp_ne_u32 vcc, 0, v12
  s_cbranch_vccnz L_poll_40
L_polled_41:
  v_pk_add_f32 v[16:17], v[16:17], v[20:21]
  v_pk_add_f32 v[18:19], v[18:19], v[22:23]
  v_pk_add_f32 v[24:25], v[24:25], v[28:29]
  v_pk_add_f32 v[26:27], v[26:27], v[30:31]
  v_pk_add_f32 v[16:17], v[16:17], v[32:33]
  v_pk_add_f32 v[18:19], v[18:19], v[34:35]
  v_pk_add_f32 v[16:17], v[16:17], v[24:25]
  v_pk_add_f32 v[18:19], v[18:19], v[26:27]
  s_nop 1
  v_permlane32_swap_b32 v16, v18
  v_permlane32_swap_b32 v17, v19
  v_pk_add_f32 v[16:17], v[16:17], v[18:19]
  s_nop 1
  v_permlane16_swap_b32 v16, v17
  v_add_f32 v16, v16, v17
  s_nop 1
  v_add_f32_dpp v16, v16, v16 row_ror:2 row_mask:0xf bank_mask:0xf
  s_nop 1
  v_add_f32_dpp v16, v16, v16 row_ror:4 row_mask:0xf bank_mask:0xf
  s_nop 1
  v_add_f32_dpp v16, v16, v16 row_ror:8 row_mask:0xf bank_mask:0xf
  v_cvt_pk_bf16_f32 v12, v16, v16
  v_lshlrev_b32 v16, 16, v12
  v_add_f32 v120, v120, v16
  v_cvt_pk_bf16_f32 v120, v120, v120
  s_mov_b32 exec_lo, 0x00030003
  s_mov_b32 exec_hi, 0x00030003
  global_store_short v121, v120, s[22:23]
  s_cmp_eq_u32 s53, 0
  s_cbranch_scc0 L_noep_42
  v_mov_b32 v12, 48
  ds_read_b32 v13, v12
  v_mov_b32 v14, 0
  s_add_u32 s32, s26, 917504
  s_addc_u32 s33, s27, 0
  s_mov_b64 exec, 1
  s_waitcnt lgkmcnt(0)
  global_store_dword v14, v13, s[32:33]
L_noep_42:
  s_mov_b64 exec, -1
L_RED_done:
  s_endpgm
.p2align 6
L_FFN_C:
  s_mul_i32 s47, s28, 9
  s_add_u32 s47, s47, s29
  s_and_b32 s48, s47, 31
  s_mul_i32 s48, s48, 2304
  s_add_u32 s48, s48, 1900544
  s_add_u32 s36, s26, s48
  s_addc_u32 s37, s27, 0
  v_mov_b32 v68, v15
  v_mov_b32 v69, v15
  v_mov_b32 v70, v15
  v_mov_b32 v71, v15
  v_lshlrev_b32 v2, 3, v0
  v_mov_b32 v9, 44
  s_nop 0
L_spin_43:
  ds_read_b32 v8, v9
  s_cmp_eq_u32 s30, 0
  s_cbranch_scc1 L_spun_44
  s_sub_u32 s30, s30, 1
  s_waitcnt lgkmcnt(0)
  v_readfirstlane_b32 s51, v8
  s_cmp_ge_u32 s51, 1
  s_cbranch_scc0 L_spin_43
L_spun_44:
  s_waitcnt lgkmcnt(0)
  v_mov_b32 v9, 56
  s_nop 0
L_spin_45:
  ds_read_b32 v8, v9
  s_cmp_eq_u32 s30, 0
  s_cbranch_scc1 L_spun_46
  s_sub_u32 s30, s30, 1
  s_waitcnt lgkmcnt(0)
  v_readfirstlane_b32 s51, v8
  s_cmp_ge_u32 s51, 8
  s_cbranch_scc0 L_spin_45
L_spun_46:
  s_waitcnt lgkmcnt(0)
  s_nop 0
L_poll_47:
  global_load_dwordx4 v[60:63], v1, s[36:37] sc1
  global_load_dwordx4 v[64:67], v1, s[36:37] offset:1024 sc1
  s_mov_b64 exec, 0xffff
  global_load_dwordx4 v[68:71], v1, s[36:37] offset:2048 sc1
  s_mov_b64 exec, -1
  s_cmp_eq_u32 s30, 0
  s_cbranch_scc1 L_polled_48
  s_sub_u32 s30, s30, 1
  s_waitcnt vmcnt(0)
  v_xor_b32 v16, v60, v15
  v_xor_b32 v17, v61, v15
  v_xor_b32 v18, v62, v15
  v_xor_b32 v19, v63, v15
  v_xor_b32 v20, v64, v15
  v_xor_b32 v21, v65, v15
  v_xor_b32 v22, v66, v15
  v_xor_b32 v23, v67, v15
  v_xor_b32 v24, v68, v15
  v_xor_b32 v25, v69, v15
  v_xor_b32 v26, v70, v15
  v_xor_b32 v27, v71, v15
  v_or3_b32 v8, v16, v17, v18
  v_or3_b32 v8, v8, v19, v20
  v_or3_b32 v8, v8, v21, v22
  v_or3_b32 v8, v8, v23, v24
  v_or3_b32 v8, v8, v25, v26
  v_or_b32 v8, v8, v27
  v_and_b32 v8, 0x3ff, v8
  v_cmp_ne_u32 vcc, 0, v8
  s_cbranch_vccnz L_poll_47
L_polled_48:
  v_pk_add_f32 v[32:33], v[16:17], v[18:19]
  v_pk_add_f32 v[34:35], v[20:21], v[22:23]
  v_pk_add_f32 v[36:37], v[24:25], v[26:27]
  v_pk_add_f32 v[32:33], v[32:33], v[34:35]
  v_pk_add_f32 v[32:33], v[32:33], v[36:37]
  v_add_f32 v32, v32, v33
  s_nop 1
  v_add_f32_dpp v32, v32, v32 row_ror:8 row_mask:0xf bank_mask:0xf
  s_nop 1
  v_add_f32_dpp v32, v32, v32 row_ror:4 row_mask:0xf bank_mask:0xf
  s_nop 1
  v_add_f32_dpp v32, v32, v32 row_ror:2 row_mask:0xf bank_mask:0xf
  s_nop 1
  v_add_f32_dpp v32, v32, v32 row_ror:1 row_mask:0xf bank_mask:0xf
  v_mov_b32 v33, v32
  s_nop 1
  v_permlane16_swap_b32 v32, v33
  v_add_f32 v32, v32, v33
  v_mov_b32 v33, v32
  s_nop 1
  v_permlane32_swap_b32 v32, v33
  v_add_f32 v32, v32, v33
  v_mul_f32 v32, 0x3ae38e39, v32
  v_cvt_pk_bf16_f32 v33, v32, v32
  v_and_b32 v34, 0xffff0000, v33
  v_and_b32 v35, 0xffff0000, v33
  v_pk_add_f32 v[40:41], v[16:17], v[34:35] neg_lo:[0,1] neg_hi:[0,1]
  v_pk_add_f32 v[42:43], v[18:19], v[34:35] neg_lo:[0,1] neg_hi:[0,1]
  v_pk_add_f32 v[44:45], v[20:21], v[34:35] neg_lo:[0,1] neg_hi:[0,1]
  v_pk_add_f32 v[46:47], v[22:23], v[34:35] neg_lo:[0,1] neg_hi:[0,1]
  v_pk_add_f32 v[48:49], v[24:25], v[34:35] neg_lo:[0,1] neg_hi:[0,1]
  v_pk_add_f32 v[50:51], v[26:27], v[34:35] neg_lo:[0,1] neg_hi:[0,1]
  v_cvt_pk_bf16_f32 v52, v40, v41
  v_cvt_pk_bf16_f32 v53, v42, v43
  v_cvt_pk_bf16_f32 v54, v44, v45
  v_cvt_pk_bf16_f32 v55, v46, v47
  v_cvt_pk_bf16_f32 v56, v48, v49
  v_cvt_pk_bf16_f32 v57, v50, v51
  ds_write_b64 v2, v[52:53] offset:6656
  ds_write_b64 v2, v[54:55] offset:7168
  s_mov_b64 exec, 0xffff
  ds_write_b64 v2, v[56:57] offset:7680
  s_mov_b64 exec, -1
  s_waitcnt lgkmcnt(0)
  s_barrier
  s_setprio 0
  v_mov_b32 v33, v32
  v_pk_add_f32 v[40:41], v[16:17], v[32:33] neg_lo:[0,1] neg_hi:[0,1]
  v_pk_add_f32 v[42:43], v[18:19], v[32:33] neg_lo:[0,1] neg_hi:[0,1]
  v_pk_add_f32 v[44:45], v[20:21], v[32:33] neg_lo:[0,1] neg_hi:[0,1]
  v_pk_add_f32 v[46:47], v[22:23], v[32:33] neg_lo:[0,1] neg_hi:[0,1]
  v_mov_b32 v48, 0
  v_mov_b32 v49, 0
  v_mov_b32 v50, 0
  v_mov_b32 v51, 0
  s_mov_b64 exec, 0xffff
  v_pk_add_f32 v[48:49], v[24:25], v[32:33] neg_lo:[0,1] neg_hi:[0,1]
  v_pk_add_f32 v[50:51], v[26:27], v[32:33] neg_lo:[0,1] neg_hi:[0,1]
  s_mov_b64 exec, -1
  v_pk_mul_f32 v[34:35], v[40:41], v[40:41]
  v_pk_fma_f32 v[34:35], v[42:43], v[42:43], v[34:35]
  v_pk_fma_f32 v[34:35], v[44:45], v[44:45], v[34:35]
  v_pk_fma_f32 v[34:35], v[46:47], v[46:47], v[34:35]
  v_pk_fma_f32 v[34:35], v[48:49], v[48:49], v[34:35]
  v_pk_fma_f32 v[34:35], v[50:51], v[50:51], v[34:35]
  v_add_f32 v34, v34, v35
  s_nop 1
  v_add_f32_dpp v34, v34, v34 row_ror:8 row_mask:0xf bank_mask:0xf
  s_nop 1
  v_add_f32_dpp v34, v34, v34 row_ror:4 row_mask:0xf bank_mask:0xf
  s_nop 1
  v_add_f32_dpp v34, v34, v34 row_ror:2 row_mask:0xf bank_mask:0xf
  s_nop 1
  v_add_f32_dpp v34, v34, v34 row_ror:1 row_mask:0xf bank_mask:0xf
  v_mov_b32 v35, v34
  s_nop 1
  v_permlane16_swap_b32 v34, v35
  v_add_f32 v34, v34, v35
  v_mov_b32 v35, v34
  s_nop 1
  v_permlane32_swap_b32 v34, v35
  v_add_f32 v34, v34, v35
  v_mul_f32 v34, 0x3ae38e39, v34
  v_cvt_pk_bf16_f32 v35, v34, v34
  v_lshlrev_b32 v34, 16, v35
  v_add_f32 v34, 0x3727c5ac, v34
  v_cvt_pk_bf16_f32 v35, v34, v34
  v_lshlrev_b32 v34, 16, v35
  v_sqrt_f32 v34, v34
  s_nop 0
  v_cvt_pk_bf16_f32 v35, v34, v34
  v_lshlrev_b32 v34, 16, v35
  v_rcp_f32 v34, v34
  v_mov_b32 v8, 12032
  s_mov_b64 exec, 1
  ds_write_b32 v8, v34
  s_mov_b64 exec, -1
  s_waitcnt lgkmcnt(0)
  s_barrier
  s_endpgm
.p2align 6
L_FFN:
  s_lshr_b32 s48, s28, 1
  s_mul_i32 s48, s48, 9
  s_add_u32 s48, s48, s29
  s_lshl_b32 s48, s48, 6
  s_and_b32 s49, s28, 1
  s_lshl_b32 s49, s49, 5
  s_add_u32 s52, s48, s49
  v_lshrrev_b32 v16, 4, v0
  v_bfe_u32 v9, v0, 3, 1
  v_lshl_add_u32 v8, v16, 3, v9
  s_mul_i32 s48, s3, 72
  v_add_u32 v8, s48, v8
  v_mul_u32_u24 v8, 9216, v8
  v_and_b32 v9, 3, v0
  v_lshlrev_b32 v9, 4, v9
  s_lshl_b32 s48, s52, 1
  v_add3_u32 v8, v8, v9, s48
  v_bfe_u32 v9, v0, 2, 1
  v_cmp_eq_u32 vcc, 1, v9
  v_mov_b32 v10, s16
  v_mov_b32 v11, s18
  v_cndmask_b32 v10, v10, v11, vcc
  v_mov_b32 v11, s17
  v_mov_b32 v12, s19
  v_cndmask_b32 v11, v11, v12, vcc
  v_add_co_u32 v10, vcc, v10, v8
  s_nop 1
  v_addc_co_u32 v11, vcc, 0, v11, vcc
  s_mov_b32 s48, 18432
  s_mov_b32 s49, 0
  s_mov_b32 s50, 239616
  s_mov_b32 s51, 0
  v_mul_u32_u24 v18, 55296, v16
  v_sub_u32 v18, 239616, v18
  v_mov_b32 v19, 0
  global_load_dwordx4 v[88:91], v[10:11], off nt
  v_lshl_add_u64 v[10:11], v[10:11], 0, s[48:49]
  global_load_dwordx4 v[92:95], v[10:11], off nt
  v_lshl_add_u64 v[10:11], v[10:11], 0, s[48:49]
  global_load_dwordx4 v[96:99], v[10:11], off nt
  v_lshl_add_u64 v[10:11], v[10:11], 0, s[48:49]
  global_load_dwordx4 v[100:103], v[10:11], off nt
  v_lshl_add_u64 v[10:11], v[10:11], 0, s[50:51]
  v_mov_b32 v21, 44
  s_nop 0
L_spin_51:
  ds_read_b32 v20, v21
  s_cmp_eq_u32 s30, 0
  s_cbranch_scc1 L_spun_52
  s_sub_u32 s30, s30, 1
  s_waitcnt lgkmcnt(0)
  v_readfirstlane_b32 s51, v20
  s_cmp_ge_u32 s51, 1
  s_cbranch_scc0 L_spin_51
L_spun_52:
  s_waitcnt lgkmcnt(0)
  s_mov_b32 s51, 0
  global_load_dwordx4 v[104:107], v[10:11], off nt
  v_lshl_add_u64 v[10:11], v[10:11], 0, s[48:49]
  global_load_dwordx4 v[108:111], v[10:11], off nt
  v_lshl_add_u64 v[10:11], v[10:11], 0, s[48:49]
  global_load_dwordx4 v[112:115], v[10:11], off nt
  v_lshl_add_u64 v[10:11], v[10:11], 0, s[48:49]
  global_load_dwordx4 v[116:119], v[10:11], off nt
  v_lshl_add_u64 v[10:11], v[18:19], 0, v[10:11]
  global_load_dwordx4 v[120:123], v[10:11], off nt
  s_mul_i32 s48, s3, 144
  s_add_u32 s48, s48, 6656
  v_lshlrev_b32 v8, 4, v16
  v_add_u32 v13, s48, v8
  v_lshlrev_b32 v8, 2, v16
  v_add_u32 v14, s48, v8
  v_and_b32 v8, 7, v0
  v_lshlrev_b32 v8, 5, v8
  v_bfe_u32 v9, v0, 4, 1
  v_lshl_add_u32 v8, v9, 4, v8
  v_lshrrev_b32 v9, 5, v0
  v_lshl_add_u32 v8, v9, 8, v8
  s_lshl_b32 s48, s3, 9
  s_add_u32 s48, s48, 7936
  v_add_u32 v15, s48, v8
  s_cmp_ge_u32 s3, 4
  s_cbranch_scc1 L_nodown_49
  v_lshrrev_b32 v8, 4, v0
  v_mul_u32_u24 v8, 1152, v8
  v_and_b32 v9, 15, v0
  v_lshl_add_u32 v1, v9, 4, v8
  s_lshl_b32 s48, s3, 8
  v_add_u32 v1, s48, v1
  v_lshrrev_b32 v8, 4, v0
  v_mul_u32_u24 v8, 1152, v8
  v_and_b32 v9, 15, v0
  v_lshl_add_u32 v2, v9, 4, v8
  v_add_u32 v2, 1024, v2
  v_cmp_gt_u32 vcc, 8, v9
  v_mov_b32 v8, 0x7fffffff
  s_nop 0
  v_cndmask_b32 v2, v8, v2, vcc
  s_mul_i32 s48, s52, 1152
  s_add_u32 s32, s20, s48
  s_addc_u32 s33, s21, 0
  s_and_b32 s33, s33, 0xffff
  s_mov_b32 s34, 36864
  s_mov_b32 s35, 0x20000
  s_cmp_eq_u32 s3, 0
  s_cbranch_scc0 L_dnx_53
  buffer_load_dwordx4 v[56:59], v2, s[32:35], 0 offen nt
  s_mov_b32 s48, 4608
  buffer_load_dwordx4 v[60:63], v2, s[32:35], s48 offen nt
  s_mov_b32 s48, 9216
  buffer_load_dwordx4 v[64:67], v2, s[32:35], s48 offen nt
  s_mov_b32 s48, 13824
  buffer_load_dwordx4 v[68:71], v2, s[32:35], s48 offen nt
  s_mov_b32 s48, 18432
  buffer_load_dwordx4 v[72:75], v2, s[32:35], s48 offen nt
  s_mov_b32 s48, 23040
  buffer_load_dwordx4 v[76:79], v2, s[32:35], s48 offen nt
  s_mov_b32 s48, 27648
  buffer_load_dwordx4 v[80:83], v2, s[32:35], s48 offen nt
  s_mov_b32 s48, 32256
  buffer_load_dwordx4 v[84:87], v2, s[32:35], s48 offen nt
L_dnx_53:
  buffer_load_dwordx4 v[124:127], v1, s[32:35], 0 offen nt
  s_mov_b32 s48, 4608
  buffer_load_dwordx4 v[128:131], v1, s[32:35], s48 offen nt
  s_mov_b32 s48, 9216
  buffer_load_dwordx4 v[132:135], v1, s[32:35], s48 offen nt
  s_mov_b32 s48, 13824
  buffer_load_dwordx4 v[136:139], v1, s[32:35], s48 offen nt
  s_mov_b32 s48, 18432
  buffer_load_dwordx4 v[140:143], v1, s[32:35], s48 offen nt
  s_mov_b32 s48, 23040
  buffer_load_dwordx4 v[144:147], v1, s[32:35], s48 offen nt
  s_mov_b32 s48, 27648
  buffer_load_dwordx4 v[148:151], v1, s[32:35], s48 offen nt
  s_mov_b32 s48, 32256
  buffer_load_dwordx4 v[152:155], v1, s[32:35], s48 offen nt
  s_mul_i32 s47, s28, 9
  s_add_u32 s47, s47, s29
  v_and_b32 v40, 15, v0
  s_lshl_b32 s48, s3, 4
  v_add_u32 v40, s48, v40
  v_mul_u32_u24 v40, 4608, v40
  v_lshrrev_b32 v41, 4, v0
  v_lshl_add_u32 v40, v41, 4, v40
  s_lshl_b32 s48, s47, 5
  s_add_u32 s48, s48, 540672
  s_add_u32 s44, s26, s48
  s_addc_u32 s45, s27, 0
  v_mov_b32 v9, 0
  s_nop 0
L_spin_54:
  ds_read_b32 v8, v9
  s_cmp_eq_u32 s30, 0
  s_cbranch_scc1 L_spun_55
  s_sub_u32 s30, s30, 1
  s_waitcnt lgkmcnt(0)
  v_readfirstlane_b32 s51, v8
  s_cmp_ge_u32 s51, 1
  s_cbranch_scc0 L_spin_54
L_spun_55:
  s_waitcnt lgkmcnt(0)
  v_mov_b32 v8, 48
  ds_read_b32 v42, v8
  s_movk_i32 s31, 0x3ff
  s_waitcnt lgkmcnt(0)
  v_and_b32 v42, 0x3ff, v42
  v_mov_b32 v8, -1
  v_perm_b32 v156, v8, v8, v4
  v_perm_b32 v157, v8, v8, v5
  v_perm_b32 v158, v8, v8, v6
  v_perm_b32 v159, v8, v8, v7
  v_lshrrev_b32 v8, 4, v0
  v_lshlrev_b32 v8, 10, v8
  v_and_b32 v9, 15, v0
  v_lshl_add_u32 v43, v9, 4, v8
  s_mov_b32 s47, 0xffff
  s_cmp_eq_u32 s3, 0
  s_cbranch_scc1 L_w12_56
  s_waitcnt vmcnt(12)
  v_mov_b32 v8, 56
  v_mov_b32 v9, 1
  s_mov_b64 exec, 1
  ds_add_u32 v8, v9
  s_mov_b64 exec, -1
  s_waitcnt vmcnt(8)
  s_branch L_ffj_50
L_w12_56:
  s_waitcnt vmcnt(20)
  v_mov_b32 v8, 56
  v_mov_b32 v9, 1
  s_mov_b64 exec, 1
  ds_add_u32 v8, v9
  s_mov_b64 exec, -1
  s_waitcnt vmcnt(16)
  s_branch L_ffj_50
L_nodown_49:
  s_mov_b64 s[44:45], s[26:27]
  v_mov_b32 v40, 0
  s_waitcnt vmcnt(4)
  v_mov_b32 v8, 56
  v_mov_b32 v9, 1
  s_mov_b64 exec, 1
  ds_add_u32 v8, v9
  s_mov_b64 exec, -1
  s_waitcnt vmcnt(0)
L_ffj_50:
  s_setprio 3
  s_barrier
  ds_read_b128 v[16:19], v13 offset:0
  ds_read_b128 v[20:23], v13 offset:64
  ds_read_b32 v24, v14 offset:128
  s_waitcnt lgkmcnt(2)
  v_perm_b32 v32, v16, v16, v4
  v_perm_b32 v33, v16, v16, v5
  v_perm_b32 v34, v16, v16, v6
  v_perm_b32 v35, v16, v16, v7
  v_perm_b32 v36, v17, v17, v4
  v_perm_b32 v37, v17, v17, v5
  v_perm_b32 v38, v17, v17, v6
  v_perm_b32 v39, v17, v17, v7
  v_mfma_f32_16x16x32_bf16 v[28:31], v[32:35], v[88:91], 0
  v_perm_b32 v32, v18, v18, v4
  v_perm_b32 v33, v18, v18, v5
  v_perm_b32 v34, v18, v18, v6
  v_perm_b32 v35, v18, v18, v7
  v_mfma_f32_16x16x32_bf16 v[28:31], v[36:39], v[92:95], v[28:31]
  v_perm_b32 v36, v19, v19, v4
  v_perm_b32 v37, v19, v19, v5
  v_perm_b32 v38, v19, v19, v6
  v_perm_b32 v39, v19, v19, v7
  v_mfma_f32_16x16x32_bf16 v[28:31], v[32:35], v[96:99], v[28:31]
  s_waitcnt lgkmcnt(1)
  v_perm_b32 v32, v20, v20, v4
  v_perm_b32 v33, v20, v20, v5
  v_perm_b32 v34, v20, v20, v6
  v_perm_b32 v35, v20, v20, v7
  v_mfma_f32_16x16x32_bf16 v[28:31], v[36:39], v[100:103], v[28:31]
  v_perm_b32 v36, v21, v21, v4
  v_perm_b32 v37, v21, v21, v5
  v_perm_b32 v38, v21, v21, v6
  v_perm_b32 v39, v21, v21, v7
  v_mfma_f32_16x16x32_bf16 v[28:31], v[32:35], v[104:107], v[28:31]
  v_perm_b32 v32, v22, v22, v4
  v_perm_b32 v33, v22, v22, v5
  v_perm_b32 v34, v22, v22, v6
  v_perm_b32 v35, v22, v22, v7
  v_mfma_f32_16x16x32_bf16 v[28:31], v[36:39], v[108:111], v[28:31]
  v_perm_b32 v36, v23, v23, v4
  v_perm_b32 v37, v23, v23, v5
  v_perm_b32 v38, v23, v23, v6
  v_perm_b32 v39, v23, v23, v7
  v_mfma_f32_16x16x32_bf16 v[28:31], v[32:35], v[112:115], v[28:31]
  s_waitcnt lgkmcnt(0)
  v_perm_b32 v32, v24, v24, v4
  v_perm_b32 v33, v24, v24, v5
  v_perm_b32 v34, v24, v24, v6
  v_perm_b32 v35, v24, v24, v7
  v_mfma_f32_16x16x32_bf16 v[28:31], v[36:39], v[116:119], v[28:31]
  s_nop 0
  v_mfma_f32_16x16x32_bf16 v[28:31], v[32:35], v[120:123], v[28:31]
  s_mov_b32 exec_lo, 0x00ff00ff
  s_mov_b32 exec_hi, 0xff00ff00
  s_nop 5
  ds_write_b128 v15, v[28:31]
  s_mov_b64 exec, -1
  s_waitcnt lgkmcnt(0)
  s_barrier
  s_cmp_ge_u32 s3, 4
  s_cbranch_scc1 L_FFN_done
  v_mov_b32 v8, 12032
  ds_read_b32 v45, v8
  ds_read_b128 v[12:15], v43 offset:7936
  ds_read_b128 v[16:19], v43 offset:8192
  ds_read_b128 v[20:23], v43 offset:8448
  ds_read_b128 v[24:27], v43 offset:8704
  s_waitcnt lgkmcnt(2)
  v_pk_add_f32 v[12:13], v[12:13], v[16:17]
  v_pk_add_f32 v[14:15], v[14:15], v[18:19]
  s_waitcnt lgkmcnt(0)
  v_pk_add_f32 v[20:21], v[20:21], v[24:25]
  v_pk_add_f32 v[22:23], v[22:23], v[26:27]
  v_pk_add_f32 v[12:13], v[12:13], v[20:21]
  v_pk_add_f32 v[14:15], v[14:15], v[22:23]
  s_nop 1
  v_permlane32_swap_b32 v12, v14
  v_permlane32_swap_b32 v13, v15
  v_pk_add_f32 v[12:13], v[12:13], v[14:15]
  s_nop 1
  v_permlane16_swap_b32 v12, v13
  v_add_f32 v12, v12, v13
  v_mul_f32 v12, v12, v45
  v_cvt_pk_bf16_f32 v13, v12, v12
  v_lshlrev_b32 v12, 16, v13
  v_mul_f32 v14, v12, v12
  v_mov_b32 v15, 0x3d372713
  v_mov_b32_dpp v13, v12 row_ror:8 row_mask:0xf bank_mask:0xf
  v_fma_f32 v14, v14, v15, 1.0
  v_mul_f32 v14, v14, v12
  v_mul_f32 v14, 0xc0135761, v14
  v_exp_f32 v14, v14
  s_nop 0
  v_add_f32 v14, 1.0, v14
  v_rcp_f32 v14, v14
  s_nop 0
  v_mul_f32 v12, v12, v14
  v_cvt_pk_bf16_f32 v14, v12, v12
  v_lshlrev_b32 v12, 16, v14
  v_mul_f32 v12, v12, v13
  v_cvt_pk_bf16_f32 v16, v12, v12
  s_waitcnt vmcnt(0)
  s_cmp_eq_u32 s3, 0
  s_cbranch_scc1 L_dn0_57
  v_mov_b32_dpp v18, v16 row_newbcast:0 row_mask:0xf bank_mask:0xf
  v_and_b32 v20, v18, v156
  v_and_b32 v21, v18, v157
  v_and_b32 v22, v18, v158
  v_and_b32 v23, v18, v159
  v_mov_b32_dpp v19, v16 row_newbcast:1 row_mask:0xf bank_mask:0xf
  v_and_b32 v24, v19, v156
  v_and_b32 v25, v19, v157
  v_and_b32 v26, v19, v158
  v_and_b32 v27, v19, v159
  v_mfma_f32_16x16x32_bf16 v[28:31], v[20:23], v[124:127], 0
  v_mov_b32_dpp v18, v16 row_newbcast:2 row_mask:0xf bank_mask:0xf
  v_and_b32 v20, v18, v156
  v_and_b32 v21, v18, v157
  v_and_b32 v22, v18, v158
  v_and_b32 v23, v18, v159
  v_mfma_f32_16x16x32_bf16 v[28:31], v[24:27], v[128:131], v[28:31]
  v_mov_b32_dpp v19, v16 row_newbcast:3 row_mask:0xf bank_mask:0xf
  v_and_b32 v24, v19, v156
  v_and_b32 v25, v19, v157
  v_and_b32 v26, v19, v158
  v_and_b32 v27, v19, v159
  v_mfma_f32_16x16x32_bf16 v[28:31], v[20:23], v[132:135], v[28:31]
  v_mov_b32_dpp v18, v16 row_newbcast:4 row_mask:0xf bank_mask:0xf
  v_and_b32 v20, v18, v156
  v_and_b32 v21, v18, v157
  v_and_b32 v22, v18, v158
  v_and_b32 v23, v18, v159
  v_mfma_f32_16x16x32_bf16 v[28:31], v[24:27], v[136:139], v[28:31]
  v_mov_b32_dpp v19, v16 row_newbcast:5 row_mask:0xf bank_mask:0xf
  v_and_b32 v24, v19, v156
  v_and_b32 v25, v19, v157
  v_and_b32 v26, v19, v158
  v_and_b32 v27, v19, v159
  v_mfma_f32_16x16x32_bf16 v[28:31], v[20:23], v[140:143], v[28:31]
  v_mov_b32_dpp v18, v16 row_newbcast:6 row_mask:0xf bank_mask:0xf
  v_and_b32 v20, v18, v156
  v_and_b32 v21, v18, v157
  v_and_b32 v22, v18, v158
  v_and_b32 v23, v18, v159
  v_mfma_f32_16x16x32_bf16 v[28:31], v[24:27], v[144:147], v[28:31]
  v_mov_b32_dpp v19, v16 row_newbcast:7 row_mask:0xf bank_mask:0xf
  v_and_b32 v24, v19, v156
  v_and_b32 v25, v19, v157
  v_and_b32 v26, v19, v158
  v_and_b32 v27, v19, v159
  v_mfma_f32_16x16x32_bf16 v[28:31], v[20:23], v[148:151], v[28:31]
  s_nop 0
  v_mfma_f32_16x16x32_bf16 v[28:31], v[24:27], v[152:155], v[28:31]
  s_mov_b32 exec_hi, 0
  s_nop 6
  v_bfi_b32 v28, s31, v42, v28
  v_bfi_b32 v29, s31, v42, v29
  v_bfi_b32 v30, s31, v42, v30
  v_bfi_b32 v31, s31, v42, v31
  global_store_dwordx4 v40, v[28:31], s[44:45] sc1
  s_mov_b32 exec_hi, -1
  s_endpgm
L_dn0_57:
  v_mov_b32_dpp v18, v16 row_newbcast:0 row_mask:0xf bank_mask:0xf
  v_and_b32 v20, v18, v156
  v_and_b32 v21, v18, v157
  v_and_b32 v22, v18, v158
  v_and_b32 v23, v18, v159
  v_mov_b32_dpp v19, v16 row_newbcast:1 row_mask:0xf bank_mask:0xf
  v_and_b32 v24, v19, v156
  v_and_b32 v25, v19, v157
  v_and_b32 v26, v19, v158
  v_and_b32 v27, v19, v159
  v_mfma_f32_16x16x32_bf16 v[28:31], v[20:23], v[124:127], 0
  v_mfma_f32_16x16x32_bf16 v[48:51], v[20:23], v[56:59], 0
  v_mov_b32_dpp v18, v16 row_newbcast:2 row_mask:0xf bank_mask:0xf
  v_and_b32 v20, v18, v156
  v_and_b32 v21, v18, v157
  v_and_b32 v22, v18, v158
  v_and_b32 v23, v18, v159
  v_mfma_f32_16x16x32_bf16 v[28:31], v[24:27], v[128:131], v[28:31]
  v_mfma_f32_16x16x32_bf16 v[48:51], v[24:27], v[60:63], v[48:51]
  v_mov_b32_dpp v19, v16 row_newbcast:3 row_mask:0xf bank_mask:0xf
  v_and_b32 v24, v19, v156
  v_and_b32 v25, v19, v157
  v_and_b32 v26, v19, v158
  v_and_b32 v27, v19, v159
  v_mfma_f32_16x16x32_bf16 v[28:31], v[20:23], v[132:135], v[28:31]
  v_mfma_f32_16x16x32_bf16 v[48:51], v[20:23], v[64:67], v[48:51]
  v_mov_b32_dpp v18, v16 row_newbcast:4 row_mask:0xf bank_mask:0xf
  v_and_b32 v20, v18, v156
  v_and_b32 v21, v18, v157
  v_and_b32 v22, v18, v158
  v_and_b32 v23, v18, v159
  v_mfma_f32_16x16x32_bf16 v[28:31], v[24:27], v[136:139], v[28:31]
  v_mfma_f32_16x16x32_bf16 v[48:51], v[24:27], v[68:71], v[48:51]
  v_mov_b32_dpp v19, v16 row_newbcast:5 row_mask:0xf bank_mask:0xf
  v_and_b32 v24, v19, v156
  v_and_b32 v25, v19, v157
  v_and_b32 v26, v19, v158
  v_and_b32 v27, v19, v159
  v_mfma_f32_16x16x32_bf16 v[28:31], v[20:23], v[140:143], v[28:31]
  v_mfma_f32_16x16x32_bf16 v[48:51], v[20:23], v[72:75], v[48:51]
  v_mov_b32_dpp v18, v16 row_newbcast:6 row_mask:0xf bank_mask:0xf
  v_and_b32 v20, v18, v156
  v_and_b32 v21, v18, v157
  v_and_b32 v22, v18, v158
  v_and_b32 v23, v18, v159
  v_mfma_f32_16x16x32_bf16 v[28:31], v[24:27], v[144:147], v[28:31]
  v_mfma_f32_16x16x32_bf16 v[48:51], v[24:27], v[76:79], v[48:51]
  v_mov_b32_dpp v19, v16 row_newbcast:7 row_mask:0xf bank_mask:0xf
  v_and_b32 v24, v19, v156
  v_and_b32 v25, v19, v157
  v_and_b32 v26, v19, v158
  v_and_b32 v27, v19, v159
  v_mfma_f32_16x16x32_bf16 v[28:31], v[20:23], v[148:151], v[28:31]
  v_mfma_f32_16x16x32_bf16 v[48:51], v[20:23], v[80:83], v[48:51]
  v_mfma_f32_16x16x32_bf16 v[28:31], v[24:27], v[152:155], v[28:31]
  v_mfma_f32_16x16x32_bf16 v[48:51], v[24:27], v[84:87], v[48:51]
  s_mov_b32 exec_hi, 0
  s_nop 5
  v_bfi_b32 v28, s31, v42, v28
  v_bfi_b32 v29, s31, v42, v29
  v_bfi_b32 v30, s31, v42, v30
  v_bfi_b32 v31, s31, v42, v31
  global_store_dwordx4 v40, v[28:31], s[44:45] sc1
  s_mov_b32 exec_hi, -1
  s_mov_b32 exec_lo, 0x00ff00ff
  s_mov_b32 exec_hi, 0
  s_add_u32 s44, s44, 294912
  s_addc_u32 s45, s45, 0
  v_bfi_b32 v48, s31, v42, v48
  v_bfi_b32 v49, s31, v42, v49
  v_bfi_b32 v50, s31, v42, v50
  v_bfi_b32 v51, s31, v42, v51
  global_store_dwordx4 v40, v[48:51], s[44:45] sc1
  s_mov_b64 exec, -1
  s_endpgm
L_FFN_done:
  s_endpgm
L_end:
  s_endpgm
L_code_end:
.section .rodata,"a"
.p2align 6
.amdhsa_kernel sequential_preLN__sliding_block_cached__geglu_ffn__decode_kernel
  .amdhsa_next_free_vgpr 168
  .amdhsa_next_free_sgpr 96
  .amdhsa_accum_offset 168
  .amdhsa_group_segment_fixed_size 0
  .amdhsa_kernarg_size 96
  .amdhsa_user_sgpr_count 2
  .amdhsa_user_sgpr_kernarg_segment_ptr 1
  .amdhsa_system_sgpr_workgroup_id_x 1
  .amdhsa_float_denorm_mode_32 3
.end_amdhsa_kernel
```
